```python
import torch

def _softmax(x, axis=-1):
    return torch.softmax(x, dim=axis)
def _gelu(x):
    return torch.nn.functional.gelu(x, approximate="tanh")
def _silu(x):
    return torch.nn.functional.silu(x)
def _sigmoid(x):
    return torch.sigmoid(x)
def _layernorm(x, axis=-1, eps=1e-5):
    m = x.mean(dim=axis, keepdim=True)
    v = x.var(dim=axis, keepdim=True, unbiased=False)
    return (x - m) / torch.sqrt(v + eps)
def _scatter_add(tgt, idx, src, axis=0):
    return tgt.clone().index_add_(axis, idx, src)
def _segment_sum(src, seg, n):
    out = torch.zeros((n,) + src.shape[1:], dtype=src.dtype)
    return out.index_add_(0, seg, src)
def _pad(x, pw):
    flat = tuple(v for pair in reversed(pw) for v in pair)
    return torch.nn.functional.pad(x, flat)

kernel_name = 'interleave_layers__softmax_full_mha__dense_activation_mish__prompt'

def setup_inputs():

    _w = (lambda a: (lambda t: t.to(torch.bfloat16) if t.is_floating_point() else t)(torch.as_tensor(a)))
    def _A_setup():
        B, S, D = 1, 2048, 448
        return {
            "x": _w((lambda *s: torch.randn(*s, dtype=torch.bfloat16) * 0.05)(B, S, D)),
            "wqkv": _w((lambda *s: torch.randn(*s, dtype=torch.bfloat16) * 0.05)(D, 3 * D)),
            "wo": _w((lambda *s: torch.randn(*s, dtype=torch.bfloat16) * 0.05)(D, D)),
        }
    _A_in = _A_setup()

    def _B_setup():
        B, S, D, F = 1, 2048, 448, 1792
        return {
            "x": _w((lambda *s: torch.randn(*s, dtype=torch.bfloat16) * 0.05)(B, S, D)),
            "w1": _w((lambda *s: torch.randn(*s, dtype=torch.bfloat16) * 1.6)(D, F) * (D ** -0.5)),
            "b1": _w((lambda *s: torch.randn(*s, dtype=torch.bfloat16) * 0.2)(F)),
            "w2": _w((lambda *s: torch.randn(*s, dtype=torch.bfloat16) * 0.2)(F, D) * (F ** -0.5)),
        }
    _B_in = _B_setup()

    return {
        "A_x": _A_in["x"],
        "A_wqkv": _A_in["wqkv"],
        "A_wo": _A_in["wo"],
        "B_x": _B_in["x"],
        "B_w1": _B_in["w1"],
        "B_b1": _B_in["b1"],
        "B_w2": _B_in["w2"],
    }

def reference(A_x, A_wqkv, A_wo, B_x, B_w1, B_b1, B_w2):
    def _A_ref(x, wqkv, wo):
        B, S, D = x.shape
        H = 16; Dh = D // H
        qkv = (lambda x, *d: x.permute(*d))((x @ wqkv).reshape(B, S, 3, H, Dh), 2, 0, 3, 1, 4)
        q, k, v = qkv[0], qkv[1], qkv[2]
        scale = Dh ** -0.5
        scores = torch.einsum("bhqd,bhkd->bhqk", q, k) * scale
        p = _softmax(scores, axis=-1)
        o = torch.einsum("bhqk,bhkd->bhqd", p, v)
        return (lambda x, *d: x.permute(*d))(o, 0, 2, 1, 3).reshape(B, S, D) @ wo

    def _B_ref(x, w1, b1, w2):
        h = torch.einsum("bsd,df->bsf", x, w1) + b1
        sp = torch.log1p(torch.exp(-torch.abs(h))) + torch.where(h > 0, h, torch.zeros_like(h))
        act = h * torch.tanh(sp)
        return torch.einsum("bsf,fd->bsd", act, w2)

    x = A_x
    x = x + _A_ref(_layernorm(x, axis=-1), A_wqkv, A_wo)
    x = x + _B_ref(_layernorm(x, axis=-1), B_w1, B_b1, B_w2)
    x = x + _A_ref(_layernorm(x, axis=-1), A_wqkv, A_wo)
    x = x + _B_ref(_layernorm(x, axis=-1), B_w1, B_b1, B_w2)
    return x
```

```asm
; @launch kernel=interleave_layers__softmax_full_mha__dense_activation_mish__prompt_kernel grid=(252,1,1) block=(256,1,1) lds=16448
; @launch kernel=main_kernel grid=(256,1,1) block=(512,1,1) lds=163840
.amdgcn_target "amdgcn-amd-amdhsa--gfx950"
.text
.globl interleave_layers__softmax_full_mha__dense_activation_mish__prompt_kernel
.p2align 8
.type interleave_layers__softmax_full_mha__dense_activation_mish__prompt_kernel,@function
interleave_layers__softmax_full_mha__dense_activation_mish__prompt_kernel:
    s_cmp_ge_u32 s2, 252
    s_cbranch_scc1 interleave_layers__softmax_full_mha__dense_activation_mish__prompt_kernel_end
    s_load_dwordx2 s[4:5], s[0:1], 72
    s_load_dwordx2 s[8:9], s[0:1], 0
    s_load_dwordx2 s[12:13], s[0:1], 8
    s_load_dwordx2 s[16:17], s[0:1], 16
    s_load_dwordx2 s[20:21], s[0:1], 32
    s_load_dwordx2 s[24:25], s[0:1], 40
    s_load_dwordx2 s[28:29], s[0:1], 48
    v_lshrrev_b32 v2, 6, v0
    v_and_b32 v1, 63, v0
    s_nop 0
    v_readfirstlane_b32 s3, v2
    s_waitcnt lgkmcnt(0)
    s_mov_b32 s6, 0x10000000
    s_mov_b32 s7, 0x00020000
    s_mov_b32 s10, 0x1c0000
    s_mov_b32 s11, 0x00020000
    s_mov_b32 s14, 0x126000
    s_mov_b32 s15, 0x00020000
    s_mov_b32 s18, 0x62000
    s_mov_b32 s19, 0x00020000
    s_mov_b32 s22, 0x188000
    s_mov_b32 s23, 0x00020000
    s_mov_b32 s26, 0xe00
    s_mov_b32 s27, 0x00020000
    s_mov_b32 s30, 0x188000
    s_mov_b32 s31, 0x00020000
    v_lshrrev_b32 v3, 5, v1
    v_and_b32 v4, 31, v1
    v_lshlrev_b32 v5, 4, v1
    s_cmp_ge_u32 s2, 32
    s_cbranch_scc1 prep_nf
    s_cmp_lg_u32 s3, 0
    s_cbranch_scc1 prep_nf
    v_mov_b32 v8, 0
    v_mov_b32 v9, 0
    v_mov_b32 v10, 0
    v_mov_b32 v11, 0
    s_lshl_b32 s32, s2, 10
    s_add_u32 s32, s32, 0xf40000
    buffer_store_dwordx4 v[8:11], v5, s[4:7], s32 offen
    s_nop 1
prep_nf:
    s_cmp_ge_u32 s2, 224
    s_cbranch_scc1 prep_4
    s_cmp_ge_u32 s2, 168
    s_cbranch_scc1 prep_3
    s_cmp_ge_u32 s2, 112
    s_cbranch_scc1 prep_2
    s_cmp_ge_u32 s2, 64
    s_cbranch_scc1 prep_1
    v_mul_u32_u24 v6, 896, v4
    v_lshl_add_u32 v6, v3, 4, v6
    s_mul_i32 s32, s2, 32*896
    s_lshl_b32 s33, s3, 6
    s_add_u32 s32, s32, s33
    s_add_u32 s34, s32, 0
    buffer_load_dwordx4 v[16:19], v6, s[8:11], s34 offen
    buffer_load_dwordx4 v[20:23], v6, s[8:11], s34 offen offset:32
    s_add_u32 s34, s32, 256
    buffer_load_dwordx4 v[24:27], v6, s[8:11], s34 offen
    buffer_load_dwordx4 v[28:31], v6, s[8:11], s34 offen offset:32
    s_add_u32 s34, s32, 512
    buffer_load_dwordx4 v[32:35], v6, s[8:11], s34 offen
    buffer_load_dwordx4 v[36:39], v6, s[8:11], s34 offen offset:32
    s_cmp_ge_u32 s3, 2
    s_cbranch_scc1 px_5
    s_add_u32 s34, s32, 768
    buffer_load_dwordx4 v[40:43], v6, s[8:11], s34 offen
    buffer_load_dwordx4 v[44:47], v6, s[8:11], s34 offen offset:32
px_5:
    s_waitcnt vmcnt(0)
    s_mul_i32 s35, s2, 28*1024
    s_lshl_b32 s36, s3, 11
    s_add_u32 s35, s35, s36
    s_add_u32 s35, s35, 0x1000000
    s_mul_i32 s37, s2, 7168
    s_lshl_b32 s36, s3, 9
    s_add_u32 s37, s37, s36
    s_add_u32 s37, s37, 0x11c0000
    v_lshlrev_b32 v7, 4, v4
    v_mov_b32 v8, 0
    v_mov_b32 v9, 0
    v_mov_b32 v10, 0x3f803f80
    v_dot2_f32_bf16 v8, v16, v10, v8
    v_dot2_f32_bf16 v9, v16, v16, v9
    v_dot2_f32_bf16 v8, v17, v10, v8
    v_dot2_f32_bf16 v9, v17, v17, v9
    v_dot2_f32_bf16 v8, v18, v10, v8
    v_dot2_f32_bf16 v9, v18, v18, v9
    v_dot2_f32_bf16 v8, v19, v10, v8
    v_dot2_f32_bf16 v9, v19, v19, v9
    v_dot2_f32_bf16 v8, v20, v10, v8
    v_dot2_f32_bf16 v9, v20, v20, v9
    v_dot2_f32_bf16 v8, v21, v10, v8
    v_dot2_f32_bf16 v9, v21, v21, v9
    v_dot2_f32_bf16 v8, v22, v10, v8
    v_dot2_f32_bf16 v9, v22, v22, v9
    v_dot2_f32_bf16 v8, v23, v10, v8
    v_dot2_f32_bf16 v9, v23, v23, v9
    v_permlane32_swap_b32 v16, v18
    v_permlane32_swap_b32 v17, v19
    v_permlane32_swap_b32 v20, v22
    v_permlane32_swap_b32 v21, v23
    v_mov_b32 v11, v8
    s_nop 1
    v_permlane32_swap_b32 v8, v11
    s_nop 0
    v_add_f32 v8, v8, v11
    v_mov_b32 v11, v9
    s_nop 1
    v_permlane32_swap_b32 v9, v11
    s_nop 0
    v_add_f32 v9, v9, v11
    s_add_u32 s38, s35, 0
    buffer_store_dwordx4 v[16:19], v5, s[4:7], s38 offen
    buffer_store_dwordx4 v[20:23], v5, s[4:7], s38 offen offset:1024
    s_add_u32 s38, s37, 0
    s_mov_b32 exec_hi, 0
    v_mov_b32 v10, 0
    v_mov_b32 v11, 0
    buffer_store_dwordx4 v[8:11], v7, s[4:7], s38 offen
    s_mov_b32 exec_hi, -1
    s_nop 1
    v_mov_b32 v8, 0
    v_mov_b32 v9, 0
    v_mov_b32 v10, 0x3f803f80
    v_dot2_f32_bf16 v8, v24, v10, v8
    v_dot2_f32_bf16 v9, v24, v24, v9
    v_dot2_f32_bf16 v8, v25, v10, v8
    v_dot2_f32_bf16 v9, v25, v25, v9
    v_dot2_f32_bf16 v8, v26, v10, v8
    v_dot2_f32_bf16 v9, v26, v26, v9
    v_dot2_f32_bf16 v8, v27, v10, v8
    v_dot2_f32_bf16 v9, v27, v27, v9
    v_dot2_f32_bf16 v8, v28, v10, v8
    v_dot2_f32_bf16 v9, v28, v28, v9
    v_dot2_f32_bf16 v8, v29, v10, v8
    v_dot2_f32_bf16 v9, v29, v29, v9
    v_dot2_f32_bf16 v8, v30, v10, v8
    v_dot2_f32_bf16 v9, v30, v30, v9
    v_dot2_f32_bf16 v8, v31, v10, v8
    v_dot2_f32_bf16 v9, v31, v31, v9
    v_permlane32_swap_b32 v24, v26
    v_permlane32_swap_b32 v25, v27
    v_permlane32_swap_b32 v28, v30
    v_permlane32_swap_b32 v29, v31
    v_mov_b32 v11, v8
    s_nop 1
    v_permlane32_swap_b32 v8, v11
    s_nop 0
    v_add_f32 v8, v8, v11
    v_mov_b32 v11, v9
    s_nop 1
    v_permlane32_swap_b32 v9, v11
    s_nop 0
    v_add_f32 v9, v9, v11
    s_add_u32 s38, s35, 8192
    buffer_store_dwordx4 v[24:27], v5, s[4:7], s38 offen
    buffer_store_dwordx4 v[28:31], v5, s[4:7], s38 offen offset:1024
    s_add_u32 s38, s37, 2048
    s_mov_b32 exec_hi, 0
    v_mov_b32 v10, 0
    v_mov_b32 v11, 0
    buffer_store_dwordx4 v[8:11], v7, s[4:7], s38 offen
    s_mov_b32 exec_hi, -1
    s_nop 1
    v_mov_b32 v8, 0
    v_mov_b32 v9, 0
    v_mov_b32 v10, 0x3f803f80
    v_dot2_f32_bf16 v8, v32, v10, v8
    v_dot2_f32_bf16 v9, v32, v32, v9
    v_dot2_f32_bf16 v8, v33, v10, v8
    v_dot2_f32_bf16 v9, v33, v33, v9
    v_dot2_f32_bf16 v8, v34, v10, v8
    v_dot2_f32_bf16 v9, v34, v34, v9
    v_dot2_f32_bf16 v8, v35, v10, v8
    v_dot2_f32_bf16 v9, v35, v35, v9
    v_dot2_f32_bf16 v8, v36, v10, v8
    v_dot2_f32_bf16 v9, v36, v36, v9
    v_dot2_f32_bf16 v8, v37, v10, v8
    v_dot2_f32_bf16 v9, v37, v37, v9
    v_dot2_f32_bf16 v8, v38, v10, v8
    v_dot2_f32_bf16 v9, v38, v38, v9
    v_dot2_f32_bf16 v8, v39, v10, v8
    v_dot2_f32_bf16 v9, v39, v39, v9
    v_permlane32_swap_b32 v32, v34
    v_permlane32_swap_b32 v33, v35
    v_permlane32_swap_b32 v36, v38
    v_permlane32_swap_b32 v37, v39
    v_mov_b32 v11, v8
    s_nop 1
    v_permlane32_swap_b32 v8, v11
    s_nop 0
    v_add_f32 v8, v8, v11
    v_mov_b32 v11, v9
    s_nop 1
    v_permlane32_swap_b32 v9, v11
    s_nop 0
    v_add_f32 v9, v9, v11
    s_add_u32 s38, s35, 16384
    buffer_store_dwordx4 v[32:35], v5, s[4:7], s38 offen
    buffer_store_dwordx4 v[36:39], v5, s[4:7], s38 offen offset:1024
    s_add_u32 s38, s37, 4096
    s_mov_b32 exec_hi, 0
    v_mov_b32 v10, 0
    v_mov_b32 v11, 0
    buffer_store_dwordx4 v[8:11], v7, s[4:7], s38 offen
    s_mov_b32 exec_hi, -1
    s_nop 1
    s_cmp_ge_u32 s3, 2
    s_cbranch_scc1 px_6
    v_mov_b32 v8, 0
    v_mov_b32 v9, 0
    v_mov_b32 v10, 0x3f803f80
    v_dot2_f32_bf16 v8, v40, v10, v8
    v_dot2_f32_bf16 v9, v40, v40, v9
    v_dot2_f32_bf16 v8, v41, v10, v8
    v_dot2_f32_bf16 v9, v41, v41, v9
    v_dot2_f32_bf16 v8, v42, v10, v8
    v_dot2_f32_bf16 v9, v42, v42, v9
    v_dot2_f32_bf16 v8, v43, v10, v8
    v_dot2_f32_bf16 v9, v43, v43, v9
    v_dot2_f32_bf16 v8, v44, v10, v8
    v_dot2_f32_bf16 v9, v44, v44, v9
    v_dot2_f32_bf16 v8, v45, v10, v8
    v_dot2_f32_bf16 v9, v45, v45, v9
    v_dot2_f32_bf16 v8, v46, v10, v8
    v_dot2_f32_bf16 v9, v46, v46, v9
    v_dot2_f32_bf16 v8, v47, v10, v8
    v_dot2_f32_bf16 v9, v47, v47, v9
    v_permlane32_swap_b32 v40, v42
    v_permlane32_swap_b32 v41, v43
    v_permlane32_swap_b32 v44, v46
    v_permlane32_swap_b32 v45, v47
    v_mov_b32 v11, v8
    s_nop 1
    v_permlane32_swap_b32 v8, v11
    s_nop 0
    v_add_f32 v8, v8, v11
    v_mov_b32 v11, v9
    s_nop 1
    v_permlane32_swap_b32 v9, v11
    s_nop 0
    v_add_f32 v9, v9, v11
    s_add_u32 s38, s35, 24576
    buffer_store_dwordx4 v[40:43], v5, s[4:7], s38 offen
    buffer_store_dwordx4 v[44:47], v5, s[4:7], s38 offen offset:1024
    s_add_u32 s38, s37, 6144
    s_mov_b32 exec_hi, 0
    v_mov_b32 v10, 0
    v_mov_b32 v11, 0
    buffer_store_dwordx4 v[8:11], v7, s[4:7], s38 offen
    s_mov_b32 exec_hi, -1
    s_nop 1
px_6:
    s_waitcnt vmcnt(0)
    s_endpgm
prep_1:
    s_sub_u32 s42, s2, 64
    s_lshr_b32 s43, s42, 4
    s_and_b32 s44, s42, 15
    s_mul_i32 s45, s3, 301056
    s_mul_i32 s46, s43, 896
    s_add_u32 s45, s45, s46
    s_mul_i32 s46, s44, 56
    s_add_u32 s45, s45, s46
    s_mul_i32 s47, s44, 28
    s_mul_i32 s46, s3, 7
    s_add_u32 s47, s47, s46
    s_mul_i32 s47, s47, 3
    s_add_u32 s47, s47, s43
    s_lshl_b32 s47, s47, 10
    s_add_u32 s47, s47, 0x900000
    v_mul_u32_u24 v6, 10752, v3
    v_lshl_add_u32 v6, v4, 1, v6
    v_cmp_gt_u32 vcc, 28, v4
    v_mov_b32 v7, 0x40000000
    s_nop 0
    v_cndmask_b32 v6, v7, v6, vcc
    s_add_u32 s40, s45, 0
    buffer_load_ushort v16, v6, s[12:15], s40 offen
    s_add_u32 s40, s45, 2688
    buffer_load_ushort v17, v6, s[12:15], s40 offen
    s_add_u32 s40, s45, 5376
    buffer_load_ushort v18, v6, s[12:15], s40 offen
    s_add_u32 s40, s45, 8064
    buffer_load_ushort v19, v6, s[12:15], s40 offen
    s_add_u32 s40, s45, 21504
    buffer_load_ushort v20, v6, s[12:15], s40 offen
    s_add_u32 s40, s45, 24192
    buffer_load_ushort v21, v6, s[12:15], s40 offen
    s_add_u32 s40, s45, 26880
    buffer_load_ushort v22, v6, s[12:15], s40 offen
    s_add_u32 s40, s45, 29568
    buffer_load_ushort v23, v6, s[12:15], s40 offen
    s_add_u32 s40, s45, 43008
    buffer_load_ushort v24, v6, s[12:15], s40 offen
    s_add_u32 s40, s45, 45696
    buffer_load_ushort v25, v6, s[12:15], s40 offen
    s_add_u32 s40, s45, 48384
    buffer_load_ushort v26, v6, s[12:15], s40 offen
    s_add_u32 s40, s45, 51072
    buffer_load_ushort v27, v6, s[12:15], s40 offen
    s_add_u32 s40, s45, 64512
    buffer_load_ushort v28, v6, s[12:15], s40 offen
    s_add_u32 s40, s45, 67200
    buffer_load_ushort v29, v6, s[12:15], s40 offen
    s_add_u32 s40, s45, 69888
    buffer_load_ushort v30, v6, s[12:15], s40 offen
    s_add_u32 s40, s45, 72576
    buffer_load_ushort v31, v6, s[12:15], s40 offen
    s_add_u32 s40, s45, 86016
    buffer_load_ushort v32, v6, s[12:15], s40 offen
    s_add_u32 s40, s45, 88704
    buffer_load_ushort v33, v6, s[12:15], s40 offen
    s_add_u32 s40, s45, 91392
    buffer_load_ushort v34, v6, s[12:15], s40 offen
    s_add_u32 s40, s45, 94080
    buffer_load_ushort v35, v6, s[12:15], s40 offen
    s_add_u32 s40, s45, 107520
    buffer_load_ushort v36, v6, s[12:15], s40 offen
    s_add_u32 s40, s45, 110208
    buffer_load_ushort v37, v6, s[12:15], s40 offen
    s_add_u32 s40, s45, 112896
    buffer_load_ushort v38, v6, s[12:15], s40 offen
    s_add_u32 s40, s45, 115584
    buffer_load_ushort v39, v6, s[12:15], s40 offen
    s_add_u32 s40, s45, 129024
    buffer_load_ushort v40, v6, s[12:15], s40 offen
    s_add_u32 s40, s45, 131712
    buffer_load_ushort v41, v6, s[12:15], s40 offen
    s_add_u32 s40, s45, 134400
    buffer_load_ushort v42, v6, s[12:15], s40 offen
    s_add_u32 s40, s45, 137088
    buffer_load_ushort v43, v6, s[12:15], s40 offen
    s_add_u32 s40, s45, 150528
    buffer_load_ushort v44, v6, s[12:15], s40 offen
    s_add_u32 s40, s45, 153216
    buffer_load_ushort v45, v6, s[12:15], s40 offen
    s_add_u32 s40, s45, 155904
    buffer_load_ushort v46, v6, s[12:15], s40 offen
    s_add_u32 s40, s45, 158592
    buffer_load_ushort v47, v6, s[12:15], s40 offen
    s_add_u32 s40, s45, 172032
    buffer_load_ushort v48, v6, s[12:15], s40 offen
    s_add_u32 s40, s45, 174720
    buffer_load_ushort v49, v6, s[12:15], s40 offen
    s_add_u32 s40, s45, 177408
    buffer_load_ushort v50, v6, s[12:15], s40 offen
    s_add_u32 s40, s45, 180096
    buffer_load_ushort v51, v6, s[12:15], s40 offen
    s_add_u32 s40, s45, 193536
    buffer_load_ushort v52, v6, s[12:15], s40 offen
    s_add_u32 s40, s45, 196224
    buffer_load_ushort v53, v6, s[12:15], s40 offen
    s_add_u32 s40, s45, 198912
    buffer_load_ushort v54, v6, s[12:15], s40 offen
    s_add_u32 s40, s45, 201600
    buffer_load_ushort v55, v6, s[12:15], s40 offen
    s_add_u32 s40, s45, 215040
    buffer_load_ushort v56, v6, s[12:15], s40 offen
    s_add_u32 s40, s45, 217728
    buffer_load_ushort v57, v6, s[12:15], s40 offen
    s_add_u32 s40, s45, 220416
    buffer_load_ushort v58, v6, s[12:15], s40 offen
    s_add_u32 s40, s45, 223104
    buffer_load_ushort v59, v6, s[12:15], s40 offen
    s_add_u32 s40, s45, 236544
    buffer_load_ushort v60, v6, s[12:15], s40 offen
    s_add_u32 s40, s45, 239232
    buffer_load_ushort v61, v6, s[12:15], s40 offen
    s_add_u32 s40, s45, 241920
    buffer_load_ushort v62, v6, s[12:15], s40 offen
    s_add_u32 s40, s45, 244608
    buffer_load_ushort v63, v6, s[12:15], s40 offen
    s_add_u32 s40, s45, 258048
    buffer_load_ushort v64, v6, s[12:15], s40 offen
    s_add_u32 s40, s45, 260736
    buffer_load_ushort v65, v6, s[12:15], s40 offen
    s_add_u32 s40, s45, 263424
    buffer_load_ushort v66, v6, s[12:15], s40 offen
    s_add_u32 s40, s45, 266112
    buffer_load_ushort v67, v6, s[12:15], s40 offen
    s_add_u32 s40, s45, 279552
    buffer_load_ushort v68, v6, s[12:15], s40 offen
    s_add_u32 s40, s45, 282240
    buffer_load_ushort v69, v6, s[12:15], s40 offen
    s_add_u32 s40, s45, 284928
    buffer_load_ushort v70, v6, s[12:15], s40 offen
    s_add_u32 s40, s45, 287616
    buffer_load_ushort v71, v6, s[12:15], s40 offen
    s_waitcnt vmcnt(0)
    v_lshl_or_b32 v80, v17, 16, v16
    v_lshl_or_b32 v81, v19, 16, v18
    v_lshl_or_b32 v82, v21, 16, v20
    v_lshl_or_b32 v83, v23, 16, v22
    s_add_u32 s40, s47, 0
    buffer_store_dwordx4 v[80:83], v5, s[4:7], s40 offen
    v_lshl_or_b32 v84, v25, 16, v24
    v_lshl_or_b32 v85, v27, 16, v26
    v_lshl_or_b32 v86, v29, 16, v28
    v_lshl_or_b32 v87, v31, 16, v30
    s_add_u32 s40, s47, 3072
    buffer_store_dwordx4 v[84:87], v5, s[4:7], s40 offen
    v_lshl_or_b32 v88, v33, 16, v32
    v_lshl_or_b32 v89, v35, 16, v34
    v_lshl_or_b32 v90, v37, 16, v36
    v_lshl_or_b32 v91, v39, 16, v38
    s_add_u32 s40, s47, 6144
    buffer_store_dwordx4 v[88:91], v5, s[4:7], s40 offen
    v_lshl_or_b32 v92, v41, 16, v40
    v_lshl_or_b32 v93, v43, 16, v42
    v_lshl_or_b32 v94, v45, 16, v44
    v_lshl_or_b32 v95, v47, 16, v46
    s_add_u32 s40, s47, 9216
    buffer_store_dwordx4 v[92:95], v5, s[4:7], s40 offen
    v_lshl_or_b32 v96, v49, 16, v48
    v_lshl_or_b32 v97, v51, 16, v50
    v_lshl_or_b32 v98, v53, 16, v52
    v_lshl_or_b32 v99, v55, 16, v54
    s_add_u32 s40, s47, 12288
    buffer_store_dwordx4 v[96:99], v5, s[4:7], s40 offen
    v_lshl_or_b32 v100, v57, 16, v56
    v_lshl_or_b32 v101, v59, 16, v58
    v_lshl_or_b32 v102, v61, 16, v60
    v_lshl_or_b32 v103, v63, 16, v62
    s_add_u32 s40, s47, 15360
    buffer_store_dwordx4 v[100:103], v5, s[4:7], s40 offen
    v_lshl_or_b32 v104, v65, 16, v64
    v_lshl_or_b32 v105, v67, 16, v66
    v_lshl_or_b32 v106, v69, 16, v68
    v_lshl_or_b32 v107, v71, 16, v70
    s_add_u32 s40, s47, 18432
    buffer_store_dwordx4 v[104:107], v5, s[4:7], s40 offen
    s_cmp_eq_u32 s43, 2
    s_cbranch_scc1 pq_7
    v_mov_b32 v112, 0x3f803f80
    v_mov_b32 v113, 0x3f803f80
    v_mov_b32 v114, 0x3f803f80
    v_mov_b32 v115, 0x3f803f80
    s_nop 1
    v_mfma_f32_32x32x16_bf16 v[16:31], v[80:83], v[112:115], 0
    v_mfma_f32_32x32x16_bf16 v[16:31], v[84:87], v[112:115], v[16:31]
    v_mfma_f32_32x32x16_bf16 v[16:31], v[88:91], v[112:115], v[16:31]
    v_mfma_f32_32x32x16_bf16 v[16:31], v[92:95], v[112:115], v[16:31]
    v_mfma_f32_32x32x16_bf16 v[16:31], v[96:99], v[112:115], v[16:31]
    v_mfma_f32_32x32x16_bf16 v[16:31], v[100:103], v[112:115], v[16:31]
    v_mfma_f32_32x32x16_bf16 v[16:31], v[104:107], v[112:115], v[16:31]
    s_nop 15
    s_branch pq_8
pq_7:
    v_mov_b32 v112, 0x3f803f80
    v_mov_b32 v113, 0x3f803f80
    v_mov_b32 v114, 0x3f803f80
    v_mov_b32 v115, 0x3f803f80
    s_nop 1
    v_mfma_f32_32x32x16_bf16 v[16:31], v[112:115], v[80:83], 0
    v_mfma_f32_32x32x16_bf16 v[16:31], v[112:115], v[84:87], v[16:31]
    v_mfma_f32_32x32x16_bf16 v[16:31], v[112:115], v[88:91], v[16:31]
    v_mfma_f32_32x32x16_bf16 v[16:31], v[112:115], v[92:95], v[16:31]
    v_mfma_f32_32x32x16_bf16 v[16:31], v[112:115], v[96:99], v[16:31]
    v_mfma_f32_32x32x16_bf16 v[16:31], v[112:115], v[100:103], v[16:31]
    v_mfma_f32_32x32x16_bf16 v[16:31], v[112:115], v[104:107], v[16:31]
    s_nop 15
pq_8:
    s_lshl_b32 s41, s3, 12
    v_add_u32 v6, s41, v5
    ds_write_b128 v6, v[16:19] offset:0
    ds_write_b128 v6, v[20:23] offset:1024
    ds_write_b128 v6, v[24:27] offset:2048
    ds_write_b128 v6, v[28:31] offset:3072
    s_waitcnt lgkmcnt(0)
    s_barrier
    s_cmp_lg_u32 s3, 0
    s_cbranch_scc1 interleave_layers__softmax_full_mha__dense_activation_mish__prompt_kernel_end
    ds_read_b128 v[32:35], v5 offset:4096
    ds_read_b128 v[36:39], v5 offset:5120
    ds_read_b128 v[40:43], v5 offset:6144
    ds_read_b128 v[44:47], v5 offset:7168
    s_waitcnt lgkmcnt(0)
    v_add_f32 v16, v16, v32
    v_add_f32 v17, v17, v33
    v_add_f32 v18, v18, v34
    v_add_f32 v19, v19, v35
    v_add_f32 v20, v20, v36
    v_add_f32 v21, v21, v37
    v_add_f32 v22, v22, v38
    v_add_f32 v23, v23, v39
    v_add_f32 v24, v24, v40
    v_add_f32 v25, v25, v41
    v_add_f32 v26, v26, v42
    v_add_f32 v27, v27, v43
    v_add_f32 v28, v28, v44
    v_add_f32 v29, v29, v45
    v_add_f32 v30, v30, v46
    v_add_f32 v31, v31, v47
    ds_read_b128 v[32:35], v5 offset:8192
    ds_read_b128 v[36:39], v5 offset:9216
    ds_read_b128 v[40:43], v5 offset:10240
    ds_read_b128 v[44:47], v5 offset:11264
    s_waitcnt lgkmcnt(0)
    v_add_f32 v16, v16, v32
    v_add_f32 v17, v17, v33
    v_add_f32 v18, v18, v34
    v_add_f32 v19, v19, v35
    v_add_f32 v20, v20, v36
    v_add_f32 v21, v21, v37
    v_add_f32 v22, v22, v38
    v_add_f32 v23, v23, v39
    v_add_f32 v24, v24, v40
    v_add_f32 v25, v25, v41
    v_add_f32 v26, v26, v42
    v_add_f32 v27, v27, v43
    v_add_f32 v28, v28, v44
    v_add_f32 v29, v29, v45
    v_add_f32 v30, v30, v46
    v_add_f32 v31, v31, v47
    ds_read_b128 v[32:35], v5 offset:12288
    ds_read_b128 v[36:39], v5 offset:13312
    ds_read_b128 v[40:43], v5 offset:14336
    ds_read_b128 v[44:47], v5 offset:15360
    s_waitcnt lgkmcnt(0)
    v_add_f32 v16, v16, v32
    v_add_f32 v17, v17, v33
    v_add_f32 v18, v18, v34
    v_add_f32 v19, v19, v35
    v_add_f32 v20, v20, v36
    v_add_f32 v21, v21, v37
    v_add_f32 v22, v22, v38
    v_add_f32 v23, v23, v39
    v_add_f32 v24, v24, v40
    v_add_f32 v25, v25, v41
    v_add_f32 v26, v26, v42
    v_add_f32 v27, v27, v43
    v_add_f32 v28, v28, v44
    v_add_f32 v29, v29, v45
    v_add_f32 v30, v30, v46
    v_add_f32 v31, v31, v47
    s_lshl_b32 s46, s44, 9
    s_lshl_b32 s48, s43, 7
    s_add_u32 s46, s46, s48
    s_add_u32 s46, s46, 0xf00000
    s_cmp_eq_u32 s43, 2
    s_cbranch_scc1 pq_9
    v_lshlrev_b32 v6, 6, v3
    s_mov_b32 exec_lo, 1
    s_mov_b32 exec_hi, 1
    buffer_store_dwordx4 v[16:19], v6, s[4:7], s46 offen offset:0
    buffer_store_dwordx4 v[20:23], v6, s[4:7], s46 offen offset:16
    buffer_store_dwordx4 v[24:27], v6, s[4:7], s46 offen offset:32
    buffer_store_dwordx4 v[28:31], v6, s[4:7], s46 offen offset:48
    s_mov_b32 exec_lo, -1
    s_mov_b32 exec_hi, -1
    s_waitcnt vmcnt(0)
    s_endpgm
pq_9:
    v_lshlrev_b32 v6, 2, v1
    s_mov_b32 exec_hi, 0
    buffer_store_dword v16, v6, s[4:7], s46 offen
    s_waitcnt vmcnt(0)
    s_endpgm
prep_2:
    s_sub_u32 s42, s2, 112
    s_mul_i32 s45, s3, 401408
    s_lshl_b32 s46, s42, 6
    s_add_u32 s45, s45, s46
    s_mul_i32 s47, s42, 28
    s_mul_i32 s46, s3, 7
    s_add_u32 s47, s47, s46
    s_lshl_b32 s47, s47, 10
    s_add_u32 s47, s47, 0xb00000
    v_mul_u32_u24 v6, 14336, v3
    v_lshl_add_u32 v6, v4, 1, v6
    s_add_u32 s40, s45, 0
    buffer_load_ushort v16, v6, s[20:23], s40 offen
    s_add_u32 s40, s45, 3584
    buffer_load_ushort v17, v6, s[20:23], s40 offen
    s_add_u32 s40, s45, 7168
    buffer_load_ushort v18, v6, s[20:23], s40 offen
    s_add_u32 s40, s45, 10752
    buffer_load_ushort v19, v6, s[20:23], s40 offen
    s_add_u32 s40, s45, 28672
    buffer_load_ushort v20, v6, s[20:23], s40 offen
    s_add_u32 s40, s45, 32256
    buffer_load_ushort v21, v6, s[20:23], s40 offen
    s_add_u32 s40, s45, 35840
    buffer_load_ushort v22, v6, s[20:23], s40 offen
    s_add_u32 s40, s45, 39424
    buffer_load_ushort v23, v6, s[20:23], s40 offen
    s_add_u32 s40, s45, 57344
    buffer_load_ushort v24, v6, s[20:23], s40 offen
    s_add_u32 s40, s45, 60928
    buffer_load_ushort v25, v6, s[20:23], s40 offen
    s_add_u32 s40, s45, 64512
    buffer_load_ushort v26, v6, s[20:23], s40 offen
    s_add_u32 s40, s45, 68096
    buffer_load_ushort v27, v6, s[20:23], s40 offen
    s_add_u32 s40, s45, 86016
    buffer_load_ushort v28, v6, s[20:23], s40 offen
    s_add_u32 s40, s45, 89600
    buffer_load_ushort v29, v6, s[20:23], s40 offen
    s_add_u32 s40, s45, 93184
    buffer_load_ushort v30, v6, s[20:23], s40 offen
    s_add_u32 s40, s45, 96768
    buffer_load_ushort v31, v6, s[20:23], s40 offen
    s_add_u32 s40, s45, 114688
    buffer_load_ushort v32, v6, s[20:23], s40 offen
    s_add_u32 s40, s45, 118272
    buffer_load_ushort v33, v6, s[20:23], s40 offen
    s_add_u32 s40, s45, 121856
    buffer_load_ushort v34, v6, s[20:23], s40 offen
    s_add_u32 s40, s45, 125440
    buffer_load_ushort v35, v6, s[20:23], s40 offen
    s_add_u32 s40, s45, 143360
    buffer_load_ushort v36, v6, s[20:23], s40 offen
    s_add_u32 s40, s45, 146944
    buffer_load_ushort v37, v6, s[20:23], s40 offen
    s_add_u32 s40, s45, 150528
    buffer_load_ushort v38, v6, s[20:23], s40 offen
    s_add_u32 s40, s45, 154112
    buffer_load_ushort v39, v6, s[20:23], s40 offen
    s_add_u32 s40, s45, 172032
    buffer_load_ushort v40, v6, s[20:23], s40 offen
    s_add_u32 s40, s45, 175616
    buffer_load_ushort v41, v6, s[20:23], s40 offen
    s_add_u32 s40, s45, 179200
    buffer_load_ushort v42, v6, s[20:23], s40 offen
    s_add_u32 s40, s45, 182784
    buffer_load_ushort v43, v6, s[20:23], s40 offen
    s_add_u32 s40, s45, 200704
    buffer_load_ushort v44, v6, s[20:23], s40 offen
    s_add_u32 s40, s45, 204288
    buffer_load_ushort v45, v6, s[20:23], s40 offen
    s_add_u32 s40, s45, 207872
    buffer_load_ushort v46, v6, s[20:23], s40 offen
    s_add_u32 s40, s45, 211456
    buffer_load_ushort v47, v6, s[20:23], s40 offen
    s_add_u32 s40, s45, 229376
    buffer_load_ushort v48, v6, s[20:23], s40 offen
    s_add_u32 s40, s45, 232960
    buffer_load_ushort v49, v6, s[20:23], s40 offen
    s_add_u32 s40, s45, 236544
    buffer_load_ushort v50, v6, s[20:23], s40 offen
    s_add_u32 s40, s45, 240128
    buffer_load_ushort v51, v6, s[20:23], s40 offen
    s_add_u32 s40, s45, 258048
    buffer_load_ushort v52, v6, s[20:23], s40 offen
    s_add_u32 s40, s45, 261632
    buffer_load_ushort v53, v6, s[20:23], s40 offen
    s_add_u32 s40, s45, 265216
    buffer_load_ushort v54, v6, s[20:23], s40 offen
    s_add_u32 s40, s45, 268800
    buffer_load_ushort v55, v6, s[20:23], s40 offen
    s_add_u32 s40, s45, 286720
    buffer_load_ushort v56, v6, s[20:23], s40 offen
    s_add_u32 s40, s45, 290304
    buffer_load_ushort v57, v6, s[20:23], s40 offen
    s_add_u32 s40, s45, 293888
    buffer_load_ushort v58, v6, s[20:23], s40 offen
    s_add_u32 s40, s45, 297472
    buffer_load_ushort v59, v6, s[20:23], s40 offen
    s_add_u32 s40, s45, 315392
    buffer_load_ushort v60, v6, s[20:23], s40 offen
    s_add_u32 s40, s45, 318976
    buffer_load_ushort v61, v6, s[20:23], s40 offen
    s_add_u32 s40, s45, 322560
    buffer_load_ushort v62, v6, s[20:23], s40 offen
    s_add_u32 s40, s45, 326144
    buffer_load_ushort v63, v6, s[20:23], s40 offen
    s_add_u32 s40, s45, 344064
    buffer_load_ushort v64, v6, s[20:23], s40 offen
    s_add_u32 s40, s45, 347648
    buffer_load_ushort v65, v6, s[20:23], s40 offen
    s_add_u32 s40, s45, 351232
    buffer_load_ushort v66, v6, s[20:23], s40 offen
    s_add_u32 s40, s45, 354816
    buffer_load_ushort v67, v6, s[20:23], s40 offen
    s_add_u32 s40, s45, 372736
    buffer_load_ushort v68, v6, s[20:23], s40 offen
    s_add_u32 s40, s45, 376320
    buffer_load_ushort v69, v6, s[20:23], s40 offen
    s_add_u32 s40, s45, 379904
    buffer_load_ushort v70, v6, s[20:23], s40 offen
    s_add_u32 s40, s45, 383488
    buffer_load_ushort v71, v6, s[20:23], s40 offen
    s_waitcnt vmcnt(0)
    v_lshl_or_b32 v80, v17, 16, v16
    v_lshl_or_b32 v81, v19, 16, v18
    v_lshl_or_b32 v82, v21, 16, v20
    v_lshl_or_b32 v83, v23, 16, v22
    s_add_u32 s40, s47, 0
    buffer_store_dwordx4 v[80:83], v5, s[4:7], s40 offen
    v_lshl_or_b32 v84, v25, 16, v24
    v_lshl_or_b32 v85, v27, 16, v26
    v_lshl_or_b32 v86, v29, 16, v28
    v_lshl_or_b32 v87, v31, 16, v30
    s_add_u32 s40, s47, 1024
    buffer_store_dwordx4 v[84:87], v5, s[4:7], s40 offen
    v_lshl_or_b32 v88, v33, 16, v32
    v_lshl_or_b32 v89, v35, 16, v34
    v_lshl_or_b32 v90, v37, 16, v36
    v_lshl_or_b32 v91, v39, 16, v38
    s_add_u32 s40, s47, 2048
    buffer_store_dwordx4 v[88:91], v5, s[4:7], s40 offen
    v_lshl_or_b32 v92, v41, 16, v40
    v_lshl_or_b32 v93, v43, 16, v42
    v_lshl_or_b32 v94, v45, 16, v44
    v_lshl_or_b32 v95, v47, 16, v46
    s_add_u32 s40, s47, 3072
    buffer_store_dwordx4 v[92:95], v5, s[4:7], s40 offen
    v_lshl_or_b32 v96, v49, 16, v48
    v_lshl_or_b32 v97, v51, 16, v50
    v_lshl_or_b32 v98, v53, 16, v52
    v_lshl_or_b32 v99, v55, 16, v54
    s_add_u32 s40, s47, 4096
    buffer_store_dwordx4 v[96:99], v5, s[4:7], s40 offen
    v_lshl_or_b32 v100, v57, 16, v56
    v_lshl_or_b32 v101, v59, 16, v58
    v_lshl_or_b32 v102, v61, 16, v60
    v_lshl_or_b32 v103, v63, 16, v62
    s_add_u32 s40, s47, 5120
    buffer_store_dwordx4 v[100:103], v5, s[4:7], s40 offen
    v_lshl_or_b32 v104, v65, 16, v64
    v_lshl_or_b32 v105, v67, 16, v66
    v_lshl_or_b32 v106, v69, 16, v68
    v_lshl_or_b32 v107, v71, 16, v70
    s_add_u32 s40, s47, 6144
    buffer_store_dwordx4 v[104:107], v5, s[4:7], s40 offen
    v_mov_b32 v112, 0x3f803f80
    v_mov_b32 v113, 0x3f803f80
    v_mov_b32 v114, 0x3f803f80
    v_mov_b32 v115, 0x3f803f80
    s_nop 1
    v_mfma_f32_32x32x16_bf16 v[16:31], v[80:83], v[112:115], 0
    v_mfma_f32_32x32x16_bf16 v[16:31], v[84:87], v[112:115], v[16:31]
    v_mfma_f32_32x32x16_bf16 v[16:31], v[88:91], v[112:115], v[16:31]
    v_mfma_f32_32x32x16_bf16 v[16:31], v[92:95], v[112:115], v[16:31]
    v_mfma_f32_32x32x16_bf16 v[16:31], v[96:99], v[112:115], v[16:31]
    v_mfma_f32_32x32x16_bf16 v[16:31], v[100:103], v[112:115], v[16:31]
    v_mfma_f32_32x32x16_bf16 v[16:31], v[104:107], v[112:115], v[16:31]
    s_nop 15
    s_lshl_b32 s41, s3, 12
    v_add_u32 v6, s41, v5
    ds_write_b128 v6, v[16:19] offset:0
    ds_write_b128 v6, v[20:23] offset:1024
    ds_write_b128 v6, v[24:27] offset:2048
    ds_write_b128 v6, v[28:31] offset:3072
    s_waitcnt lgkmcnt(0)
    s_barrier
    s_cmp_lg_u32 s3, 0
    s_cbranch_scc1 interleave_layers__softmax_full_mha__dense_activation_mish__prompt_kernel_end
    ds_read_b128 v[32:35], v5 offset:4096
    ds_read_b128 v[36:39], v5 offset:5120
    ds_read_b128 v[40:43], v5 offset:6144
    ds_read_b128 v[44:47], v5 offset:7168
    s_waitcnt lgkmcnt(0)
    v_add_f32 v16, v16, v32
    v_add_f32 v17, v17, v33
    v_add_f32 v18, v18, v34
    v_add_f32 v19, v19, v35
    v_add_f32 v20, v20, v36
    v_add_f32 v21, v21, v37
    v_add_f32 v22, v22, v38
    v_add_f32 v23, v23, v39
    v_add_f32 v24, v24, v40
    v_add_f32 v25, v25, v41
    v_add_f32 v26, v26, v42
    v_add_f32 v27, v27, v43
    v_add_f32 v28, v28, v44
    v_add_f32 v29, v29, v45
    v_add_f32 v30, v30, v46
    v_add_f32 v31, v31, v47
    ds_read_b128 v[32:35], v5 offset:8192
    ds_read_b128 v[36:39], v5 offset:9216
    ds_read_b128 v[40:43], v5 offset:10240
    ds_read_b128 v[44:47], v5 offset:11264
    s_waitcnt lgkmcnt(0)
    v_add_f32 v16, v16, v32
    v_add_f32 v17, v17, v33
    v_add_f32 v18, v18, v34
    v_add_f32 v19, v19, v35
    v_add_f32 v20, v20, v36
    v_add_f32 v21, v21, v37
    v_add_f32 v22, v22, v38
    v_add_f32 v23, v23, v39
    v_add_f32 v24, v24, v40
    v_add_f32 v25, v25, v41
    v_add_f32 v26, v26, v42
    v_add_f32 v27, v27, v43
    v_add_f32 v28, v28, v44
    v_add_f32 v29, v29, v45
    v_add_f32 v30, v30, v46
    v_add_f32 v31, v31, v47
    ds_read_b128 v[32:35], v5 offset:12288
    ds_read_b128 v[36:39], v5 offset:13312
    ds_read_b128 v[40:43], v5 offset:14336
    ds_read_b128 v[44:47], v5 offset:15360
    s_waitcnt lgkmcnt(0)
    v_add_f32 v16, v16, v32
    v_add_f32 v17, v17, v33
    v_add_f32 v18, v18, v34
    v_add_f32 v19, v19, v35
    v_add_f32 v20, v20, v36
    v_add_f32 v21, v21, v37
    v_add_f32 v22, v22, v38
    v_add_f32 v23, v23, v39
    v_add_f32 v24, v24, v40
    v_add_f32 v25, v25, v41
    v_add_f32 v26, v26, v42
    v_add_f32 v27, v27, v43
    v_add_f32 v28, v28, v44
    v_add_f32 v29, v29, v45
    v_add_f32 v30, v30, v46
    v_add_f32 v31, v31, v47
    v_mul_f32 v16, 0x3fb8aa3b, v16
    v_mul_f32 v17, 0x3fb8aa3b, v17
    v_mul_f32 v18, 0x3fb8aa3b, v18
    v_mul_f32 v19, 0x3fb8aa3b, v19
    v_mul_f32 v20, 0x3fb8aa3b, v20
    v_mul_f32 v21, 0x3fb8aa3b, v21
    v_mul_f32 v22, 0x3fb8aa3b, v22
    v_mul_f32 v23, 0x3fb8aa3b, v23
    v_mul_f32 v24, 0x3fb8aa3b, v24
    v_mul_f32 v25, 0x3fb8aa3b, v25
    v_mul_f32 v26, 0x3fb8aa3b, v26
    v_mul_f32 v27, 0x3fb8aa3b, v27
    v_mul_f32 v28, 0x3fb8aa3b, v28
    v_mul_f32 v29, 0x3fb8aa3b, v29
    v_mul_f32 v30, 0x3fb8aa3b, v30
    v_mul_f32 v31, 0x3fb8aa3b, v31
    s_lshl_b32 s46, s42, 8
    s_add_u32 s46, s46, 0xf10000
    v_lshlrev_b32 v6, 6, v3
    s_mov_b32 exec_lo, 1
    s_mov_b32 exec_hi, 1
    buffer_store_dwordx4 v[16:19], v6, s[4:7], s46 offen offset:0
    buffer_store_dwordx4 v[20:23], v6, s[4:7], s46 offen offset:16
    buffer_store_dwordx4 v[24:27], v6, s[4:7], s46 offen offset:32
    buffer_store_dwordx4 v[28:31], v6, s[4:7], s46 offen offset:48
    s_mov_b32 exec_lo, -1
    s_mov_b32 exec_hi, -1
    v_and_b32 v6, 15, v1
    v_lshrrev_b32 v7, 2, v6
    v_lshlrev_b32 v7, 3, v7
    v_and_b32 v6, 3, v6
    v_add_u32 v7, v7, v6
    v_lshrrev_b32 v6, 4, v1
    v_and_b32 v6, 1, v6
    v_lshl_add_u32 v7, v6, 2, v7
    v_lshlrev_b32 v7, 1, v7
    s_lshl_b32 s48, s42, 6
    buffer_load_ushort v8, v7, s[24:27], s48 offen
    s_waitcnt vmcnt(0)
    v_lshlrev_b32 v8, 16, v8
    v_mul_f32 v8, 0x3fb8aa3b, v8
    v_lshlrev_b32 v6, 2, v1
    s_mov_b32 exec_hi, 0
    buffer_store_dword v8, v6, s[4:7], s46 offen offset:128
    s_waitcnt vmcnt(0)
    s_endpgm
prep_3:
    s_sub_u32 s42, s2, 168
    s_lshr_b32 s43, s42, 2
    s_and_b32 s44, s42, 3
    s_mul_i32 s46, s44, 28
    s_mul_i32 s48, s3, 7
    s_add_u32 s46, s46, s48
    s_mul_i32 s45, s46, 14336
    s_lshl_b32 s48, s43, 6
    s_add_u32 s45, s45, s48
    s_mul_i32 s47, s43, 112
    s_add_u32 s47, s47, s46
    s_lshl_b32 s47, s47, 10
    s_add_u32 s47, s47, 0xd00000
    v_mul_u32_u24 v6, 3584, v3
    v_lshl_add_u32 v6, v4, 1, v6
    s_add_u32 s40, s45, 0
    buffer_load_ushort v16, v6, s[28:31], s40 offen
    s_add_u32 s40, s45, 896
    buffer_load_ushort v17, v6, s[28:31], s40 offen
    s_add_u32 s40, s45, 1792
    buffer_load_ushort v18, v6, s[28:31], s40 offen
    s_add_u32 s40, s45, 2688
    buffer_load_ushort v19, v6, s[28:31], s40 offen
    s_add_u32 s40, s45, 7168
    buffer_load_ushort v20, v6, s[28:31], s40 offen
    s_add_u32 s40, s45, 8064
    buffer_load_ushort v21, v6, s[28:31], s40 offen
    s_add_u32 s40, s45, 8960
    buffer_load_ushort v22, v6, s[28:31], s40 offen
    s_add_u32 s40, s45, 9856
    buffer_load_ushort v23, v6, s[28:31], s40 offen
    s_add_u32 s40, s45, 14336
    buffer_load_ushort v24, v6, s[28:31], s40 offen
    s_add_u32 s40, s45, 15232
    buffer_load_ushort v25, v6, s[28:31], s40 offen
    s_add_u32 s40, s45, 16128
    buffer_load_ushort v26, v6, s[28:31], s40 offen
    s_add_u32 s40, s45, 17024
    buffer_load_ushort v27, v6, s[28:31], s40 offen
    s_add_u32 s40, s45, 21504
    buffer_load_ushort v28, v6, s[28:31], s40 offen
    s_add_u32 s40, s45, 22400
    buffer_load_ushort v29, v6, s[28:31], s40 offen
    s_add_u32 s40, s45, 23296
    buffer_load_ushort v30, v6, s[28:31], s40 offen
    s_add_u32 s40, s45, 24192
    buffer_load_ushort v31, v6, s[28:31], s40 offen
    s_add_u32 s40, s45, 28672
    buffer_load_ushort v32, v6, s[28:31], s40 offen
    s_add_u32 s40, s45, 29568
    buffer_load_ushort v33, v6, s[28:31], s40 offen
    s_add_u32 s40, s45, 30464
    buffer_load_ushort v34, v6, s[28:31], s40 offen
    s_add_u32 s40, s45, 31360
    buffer_load_ushort v35, v6, s[28:31], s40 offen
    s_add_u32 s40, s45, 35840
    buffer_load_ushort v36, v6, s[28:31], s40 offen
    s_add_u32 s40, s45, 36736
    buffer_load_ushort v37, v6, s[28:31], s40 offen
    s_add_u32 s40, s45, 37632
    buffer_load_ushort v38, v6, s[28:31], s40 offen
    s_add_u32 s40, s45, 38528
    buffer_load_ushort v39, v6, s[28:31], s40 offen
    s_add_u32 s40, s45, 43008
    buffer_load_ushort v40, v6, s[28:31], s40 offen
    s_add_u32 s40, s45, 43904
    buffer_load_ushort v41, v6, s[28:31], s40 offen
    s_add_u32 s40, s45, 44800
    buffer_load_ushort v42, v6, s[28:31], s40 offen
    s_add_u32 s40, s45, 45696
    buffer_load_ushort v43, v6, s[28:31], s40 offen
    s_add_u32 s40, s45, 50176
    buffer_load_ushort v44, v6, s[28:31], s40 offen
    s_add_u32 s40, s45, 51072
    buffer_load_ushort v45, v6, s[28:31], s40 offen
    s_add_u32 s40, s45, 51968
    buffer_load_ushort v46, v6, s[28:31], s40 offen
    s_add_u32 s40, s45, 52864
    buffer_load_ushort v47, v6, s[28:31], s40 offen
    s_add_u32 s40, s45, 57344
    buffer_load_ushort v48, v6, s[28:31], s40 offen
    s_add_u32 s40, s45, 58240
    buffer_load_ushort v49, v6, s[28:31], s40 offen
    s_add_u32 s40, s45, 59136
    buffer_load_ushort v50, v6, s[28:31], s40 offen
    s_add_u32 s40, s45, 60032
    buffer_load_ushort v51, v6, s[28:31], s40 offen
    s_add_u32 s40, s45, 64512
    buffer_load_ushort v52, v6, s[28:31], s40 offen
    s_add_u32 s40, s45, 65408
    buffer_load_ushort v53, v6, s[28:31], s40 offen
    s_add_u32 s40, s45, 66304
    buffer_load_ushort v54, v6, s[28:31], s40 offen
    s_add_u32 s40, s45, 67200
    buffer_load_ushort v55, v6, s[28:31], s40 offen
    s_add_u32 s40, s45, 71680
    buffer_load_ushort v56, v6, s[28:31], s40 offen
    s_add_u32 s40, s45, 72576
    buffer_load_ushort v57, v6, s[28:31], s40 offen
    s_add_u32 s40, s45, 73472
    buffer_load_ushort v58, v6, s[28:31], s40 offen
    s_add_u32 s40, s45, 74368
    buffer_load_ushort v59, v6, s[28:31], s40 offen
    s_add_u32 s40, s45, 78848
    buffer_load_ushort v60, v6, s[28:31], s40 offen
    s_add_u32 s40, s45, 79744
    buffer_load_ushort v61, v6, s[28:31], s40 offen
    s_add_u32 s40, s45, 80640
    buffer_load_ushort v62, v6, s[28:31], s40 offen
    s_add_u32 s40, s45, 81536
    buffer_load_ushort v63, v6, s[28:31], s40 offen
    s_add_u32 s40, s45, 86016
    buffer_load_ushort v64, v6, s[28:31], s40 offen
    s_add_u32 s40, s45, 86912
    buffer_load_ushort v65, v6, s[28:31], s40 offen
    s_add_u32 s40, s45, 87808
    buffer_load_ushort v66, v6, s[28:31], s40 offen
    s_add_u32 s40, s45, 88704
    buffer_load_ushort v67, v6, s[28:31], s40 offen
    s_add_u32 s40, s45, 93184
    buffer_load_ushort v68, v6, s[28:31], s40 offen
    s_add_u32 s40, s45, 94080
    buffer_load_ushort v69, v6, s[28:31], s40 offen
    s_add_u32 s40, s45, 94976
    buffer_load_ushort v70, v6, s[28:31], s40 offen
    s_add_u32 s40, s45, 95872
    buffer_load_ushort v71, v6, s[28:31], s40 offen
    s_waitcnt vmcnt(0)
    v_lshl_or_b32 v80, v17, 16, v16
    v_lshl_or_b32 v81, v19, 16, v18
    v_lshl_or_b32 v82, v21, 16, v20
    v_lshl_or_b32 v83, v23, 16, v22
    s_add_u32 s40, s47, 0
    buffer_store_dwordx4 v[80:83], v5, s[4:7], s40 offen
    v_lshl_or_b32 v84, v25, 16, v24
    v_lshl_or_b32 v85, v27, 16, v26
    v_lshl_or_b32 v86, v29, 16, v28
    v_lshl_or_b32 v87, v31, 16, v30
    s_add_u32 s40, s47, 1024
    buffer_store_dwordx4 v[84:87], v5, s[4:7], s40 offen
    v_lshl_or_b32 v88, v33, 16, v32
    v_lshl_or_b32 v89, v35, 16, v34
    v_lshl_or_b32 v90, v37, 16, v36
    v_lshl_or_b32 v91, v39, 16, v38
    s_add_u32 s40, s47, 2048
    buffer_store_dwordx4 v[88:91], v5, s[4:7], s40 offen
    v_lshl_or_b32 v92, v41, 16, v40
    v_lshl_or_b32 v93, v43, 16, v42
    v_lshl_or_b32 v94, v45, 16, v44
    v_lshl_or_b32 v95, v47, 16, v46
    s_add_u32 s40, s47, 3072
    buffer_store_dwordx4 v[92:95], v5, s[4:7], s40 offen
    v_lshl_or_b32 v96, v49, 16, v48
    v_lshl_or_b32 v97, v51, 16, v50
    v_lshl_or_b32 v98, v53, 16, v52
    v_lshl_or_b32 v99, v55, 16, v54
    s_add_u32 s40, s47, 4096
    buffer_store_dwordx4 v[96:99], v5, s[4:7], s40 offen
    v_lshl_or_b32 v100, v57, 16, v56
    v_lshl_or_b32 v101, v59, 16, v58
    v_lshl_or_b32 v102, v61, 16, v60
    v_lshl_or_b32 v103, v63, 16, v62
    s_add_u32 s40, s47, 5120
    buffer_store_dwordx4 v[100:103], v5, s[4:7], s40 offen
    v_lshl_or_b32 v104, v65, 16, v64
    v_lshl_or_b32 v105, v67, 16, v66
    v_lshl_or_b32 v106, v69, 16, v68
    v_lshl_or_b32 v107, v71, 16, v70
    s_add_u32 s40, s47, 6144
    buffer_store_dwordx4 v[104:107], v5, s[4:7], s40 offen
    s_waitcnt vmcnt(0)
    s_endpgm
prep_4:
    s_sub_u32 s42, s2, 224
    s_lshr_b32 s43, s42, 1
    s_and_b32 s44, s42, 1
    s_lshl_b32 s46, s44, 3
    s_lshl_b32 s48, s3, 1
    s_add_u32 s46, s46, s48
    s_mul_i32 s45, s46, 25088
    s_lshl_b32 s48, s43, 6
    s_add_u32 s45, s45, s48
    s_lshl_b32 s47, s43, 5
    s_lshl_b32 s48, s46, 1
    s_add_u32 s47, s47, s48
    s_lshl_b32 s47, s47, 10
    s_add_u32 s47, s47, 0xa80000
    v_mul_u32_u24 v6, 3584, v3
    v_lshl_add_u32 v6, v4, 1, v6
    v_cmp_eq_u32 vcc, 0, v3
    v_mov_b32 v7, 0x40000000
    s_nop 0
    v_cndmask_b32 v7, v7, v6, vcc
    s_add_u32 s40, s45, 0
    buffer_load_ushort v16, v6, s[16:19], s40 offen
    s_add_u32 s40, s45, 896
    buffer_load_ushort v17, v6, s[16:19], s40 offen
    s_add_u32 s40, s45, 1792
    buffer_load_ushort v18, v6, s[16:19], s40 offen
    s_add_u32 s40, s45, 2688
    buffer_load_ushort v19, v6, s[16:19], s40 offen
    s_add_u32 s40, s45, 7168
    buffer_load_ushort v20, v6, s[16:19], s40 offen
    s_add_u32 s40, s45, 8064
    buffer_load_ushort v21, v6, s[16:19], s40 offen
    s_add_u32 s40, s45, 8960
    buffer_load_ushort v22, v6, s[16:19], s40 offen
    s_add_u32 s40, s45, 9856
    buffer_load_ushort v23, v6, s[16:19], s40 offen
    s_add_u32 s40, s45, 14336
    buffer_load_ushort v24, v6, s[16:19], s40 offen
    s_add_u32 s40, s45, 15232
    buffer_load_ushort v25, v6, s[16:19], s40 offen
    s_add_u32 s40, s45, 16128
    buffer_load_ushort v26, v6, s[16:19], s40 offen
    s_add_u32 s40, s45, 17024
    buffer_load_ushort v27, v6, s[16:19], s40 offen
    s_add_u32 s40, s45, 21504
    buffer_load_ushort v28, v7, s[16:19], s40 offen
    s_add_u32 s40, s45, 22400
    buffer_load_ushort v29, v7, s[16:19], s40 offen
    s_add_u32 s40, s45, 23296
    buffer_load_ushort v30, v7, s[16:19], s40 offen
    s_add_u32 s40, s45, 24192
    buffer_load_ushort v31, v7, s[16:19], s40 offen
    s_add_u32 s40, s45, 25088
    buffer_load_ushort v32, v6, s[16:19], s40 offen
    s_add_u32 s40, s45, 25984
    buffer_load_ushort v33, v6, s[16:19], s40 offen
    s_add_u32 s40, s45, 26880
    buffer_load_ushort v34, v6, s[16:19], s40 offen
    s_add_u32 s40, s45, 27776
    buffer_load_ushort v35, v6, s[16:19], s40 offen
    s_add_u32 s40, s45, 32256
    buffer_load_ushort v36, v6, s[16:19], s40 offen
    s_add_u32 s40, s45, 33152
    buffer_load_ushort v37, v6, s[16:19], s40 offen
    s_add_u32 s40, s45, 34048
    buffer_load_ushort v38, v6, s[16:19], s40 offen
    s_add_u32 s40, s45, 34944
    buffer_load_ushort v39, v6, s[16:19], s40 offen
    s_add_u32 s40, s45, 39424
    buffer_load_ushort v40, v6, s[16:19], s40 offen
    s_add_u32 s40, s45, 40320
    buffer_load_ushort v41, v6, s[16:19], s40 offen
    s_add_u32 s40, s45, 41216
    buffer_load_ushort v42, v6, s[16:19], s40 offen
    s_add_u32 s40, s45, 42112
    buffer_load_ushort v43, v6, s[16:19], s40 offen
    s_add_u32 s40, s45, 46592
    buffer_load_ushort v44, v7, s[16:19], s40 offen
    s_add_u32 s40, s45, 47488
    buffer_load_ushort v45, v7, s[16:19], s40 offen
    s_add_u32 s40, s45, 48384
    buffer_load_ushort v46, v7, s[16:19], s40 offen
    s_add_u32 s40, s45, 49280
    buffer_load_ushort v47, v7, s[16:19], s40 offen
    s_waitcnt vmcnt(0)
    v_lshl_or_b32 v80, v17, 16, v16
    v_lshl_or_b32 v81, v19, 16, v18
    v_lshl_or_b32 v82, v21, 16, v20
    v_lshl_or_b32 v83, v23, 16, v22
    s_add_u32 s40, s47, 0
    buffer_store_dwordx4 v[80:83], v5, s[4:7], s40 offen
    v_lshl_or_b32 v84, v25, 16, v24
    v_lshl_or_b32 v85, v27, 16, v26
    v_lshl_or_b32 v86, v29, 16, v28
    v_lshl_or_b32 v87, v31, 16, v30
    s_add_u32 s40, s47, 1024
    buffer_store_dwordx4 v[84:87], v5, s[4:7], s40 offen
    v_lshl_or_b32 v88, v33, 16, v32
    v_lshl_or_b32 v89, v35, 16, v34
    v_lshl_or_b32 v90, v37, 16, v36
    v_lshl_or_b32 v91, v39, 16, v38
    s_add_u32 s40, s47, 2048
    buffer_store_dwordx4 v[88:91], v5, s[4:7], s40 offen
    v_lshl_or_b32 v92, v41, 16, v40
    v_lshl_or_b32 v93, v43, 16, v42
    v_lshl_or_b32 v94, v45, 16, v44
    v_lshl_or_b32 v95, v47, 16, v46
    s_add_u32 s40, s47, 3072
    buffer_store_dwordx4 v[92:95], v5, s[4:7], s40 offen
interleave_layers__softmax_full_mha__dense_activation_mish__prompt_kernel_end:
    s_waitcnt vmcnt(0)
    s_endpgm
.globl main_kernel
.p2align 8
.type main_kernel,@function
main_kernel:
    s_cmp_ge_u32 s2, 256
    s_cbranch_scc1 main_kernel_end
    s_load_dwordx2 s[4:5], s[0:1], 72
    s_load_dwordx2 s[8:9], s[0:1], 56
    v_lshrrev_b32 v2, 6, v0
    v_and_b32 v1, 63, v0
    s_nop 0
    v_readfirstlane_b32 s3, v2
    s_waitcnt lgkmcnt(0)
    s_mov_b32 s6, 0x10000000
    s_mov_b32 s7, 0x00020000
    s_mov_b32 s10, 0x1c0000
    s_mov_b32 s11, 0x00020000
    v_lshrrev_b32 v3, 5, v1
    v_and_b32 v4, 31, v1
    v_lshlrev_b32 v5, 4, v1
    v_add_u32 v6, 0x10000, v5
    v_add_u32 v7, 0x20000, v5
    s_and_b32 s12, s2, 7
    s_lshr_b32 s13, s2, 3
    s_mov_b32 s14, 0
    s_mov_b32 s47, 0
    s_mov_b32 s15, 0
    s_mov_b32 s16, 15990784
    s_and_b32 s50, s13, 3
    s_lshl_b32 s51, s12, 2
    s_add_u32 s50, s50, s51
    s_lshr_b32 s51, s13, 2
    s_lshl_b32 s54, s51, 3
    s_add_u32 s54, s54, s3
    s_mul_i32 s54, s54, 28672
    s_add_u32 s54, s54, 0xb00000
    s_mov_b32 s17, 0
    s_mov_b32 s48, 0
    s_getreg_b32 s46, hwreg(HW_REG_XCC_ID, 0, 4)
    s_add_u32 s46, s46, 1
    s_cmp_lg_u32 s3, 0
    s_cbranch_scc1 xc_10
    s_lshl_b32 s18, s12, 7
    s_lshl_b32 s19, s13, 2
    s_add_u32 s18, s18, s19
    s_add_u32 s18, s18, 16005120
    v_mov_b32 v9, s46
    s_mov_b32 exec_lo, 1
    s_mov_b32 exec_hi, 0
    buffer_store_dword v9, off, s[4:7], s18 sc1
    s_mov_b32 exec_lo, -1
    s_mov_b32 exec_hi, -1
xc_10:
    s_lshr_b32 s18, s13, 1
    s_mul_i32 s19, s18, 86016
    s_add_u32 s19, s19, 0x900000
    s_lshl_b32 s20, s3, 10
    s_add_u32 s19, s19, s20
    s_add_u32 s20, s20, 65536
    s_add_u32 m0, s20, 0
    s_add_u32 s21, s19, 0
    buffer_load_dwordx4 v5, s[4:7], s21 offen lds
    s_add_u32 m0, s20, 8192
    s_add_u32 s21, s19, 8192
    buffer_load_dwordx4 v5, s[4:7], s21 offen lds
    s_add_u32 m0, s20, 16384
    s_add_u32 s21, s19, 16384
    buffer_load_dwordx4 v5, s[4:7], s21 offen lds
    s_add_u32 m0, s20, 24576
    s_add_u32 s21, s19, 24576
    buffer_load_dwordx4 v5, s[4:7], s21 offen lds
    s_add_u32 m0, s20, 32768
    s_add_u32 s21, s19, 32768
    buffer_load_dwordx4 v5, s[4:7], s21 offen lds
    s_add_u32 m0, s20, 40960
    s_add_u32 s21, s19, 40960
    buffer_load_dwordx4 v5, s[4:7], s21 offen lds
    s_add_u32 m0, s20, 49152
    s_add_u32 s21, s19, 49152
    buffer_load_dwordx4 v5, s[4:7], s21 offen lds
    s_add_u32 m0, s20, 57344
    s_add_u32 s21, s19, 57344
    buffer_load_dwordx4 v5, s[4:7], s21 offen lds
    s_add_u32 m0, s20, 65536
    s_add_u32 s21, s19, 65536
    buffer_load_dwordx4 v5, s[4:7], s21 offen lds
    s_add_u32 m0, s20, 73728
    s_add_u32 s21, s19, 73728
    buffer_load_dwordx4 v5, s[4:7], s21 offen lds
    s_cmp_ge_u32 s3, 4
    s_cbranch_scc1 wq_11
    s_add_u32 m0, s20, 81920
    s_add_u32 s21, s19, 81920
    buffer_load_dwordx4 v5, s[4:7], s21 offen lds
    s_branch wq_12
wq_11:
    s_cmp_lg_u32 s3, 4
    s_cbranch_scc1 wq_12
    s_lshl_b32 s21, s18, 9
    s_add_u32 s21, s21, 0xf00000
    s_mov_b32 m0, 151552
    s_mov_b32 exec_hi, 0
    buffer_load_dwordx4 v5, s[4:7], s21 offen lds
    s_mov_b32 exec_hi, -1
wq_12:
top_13:
    s_and_b32 s22, s13, 1
    s_lshl_b32 s23, s12, 1
    s_add_u32 s22, s22, s23
    s_lshr_b32 s23, s13, 1
    s_lshl_b32 s25, s22, 2
    s_add_u32 s25, s25, s3
    s_mul_i32 s26, s25, 28672
    s_add_u32 s26, s26, s14
    s_add_u32 s26, s26, 0x1000000
    s_mul_i32 s27, s25, 7168
    s_add_u32 s27, s27, s14
    s_add_u32 s27, s27, 0x11c0000
    s_cmp_eq_u32 s15, 0
    s_cbranch_scc1 q4_23
    s_lshl_b32 s24, s22, 7
    s_add_u32 s24, s24, 16003072
    s_waitcnt vmcnt(0)
    s_cmp_lg_u32 s3, 0
    s_cbranch_scc1 pl_25
    s_mov_b32 exec_lo, 0x3fff
    s_mov_b32 exec_hi, 0
    v_lshlrev_b32 v8, 2, v1
    s_mov_b32 s18, 0
    buffer_load_dword v16, v8, s[4:7], s24 offen sc1
    s_sleep 1
    buffer_load_dword v17, v8, s[4:7], s24 offen sc1
    s_sleep 1
    buffer_load_dword v18, v8, s[4:7], s24 offen sc1
pl_24:
    s_waitcnt vmcnt(2)
    v_cmp_eq_u32 vcc, 0, v16
    s_add_u32 s18, s18, 1
    s_nop 0
    s_cmp_eq_u32 vcc_lo, 0
    s_cbranch_scc1 pl_26
    buffer_load_dword v16, v8, s[4:7], s24 offen sc1
    s_waitcnt vmcnt(2)
    v_cmp_eq_u32 vcc, 0, v17
    s_add_u32 s18, s18, 1
    s_nop 0
    s_cmp_eq_u32 vcc_lo, 0
    s_cbranch_scc1 pl_26
    buffer_load_dword v17, v8, s[4:7], s24 offen sc1
    s_waitcnt vmcnt(2)
    v_cmp_eq_u32 vcc, 0, v18
    s_add_u32 s18, s18, 1
    s_nop 0
    s_cmp_eq_u32 vcc_lo, 0
    s_cbranch_scc1 pl_26
    buffer_load_dword v18, v8, s[4:7], s24 offen sc1
    s_cmp_lt_u32 s18, 32768
    s_cbranch_scc1 pl_24
pl_26:
    s_mov_b32 exec_lo, -1
    s_mov_b32 exec_hi, -1
pl_25:
    s_barrier
    s_branch q0_19
q4_23:
    s_barrier
q0_19:
    s_cmp_ge_u32 s3, 4
    s_cbranch_scc1 q2_20
    s_add_u32 s21, s26, 0
    buffer_load_dwordx4 v[16:19], v5, s[4:7], s21 offen offset:0 sc1
    buffer_load_dwordx4 v[20:23], v5, s[4:7], s21 offen offset:1024 sc1
    buffer_load_dwordx4 v[24:27], v5, s[4:7], s21 offen offset:2048 sc1
    buffer_load_dwordx4 v[28:31], v5, s[4:7], s21 offen offset:3072 sc1
    s_add_u32 s21, s26, 4096
    buffer_load_dwordx4 v[32:35], v5, s[4:7], s21 offen offset:0 sc1
    buffer_load_dwordx4 v[36:39], v5, s[4:7], s21 offen offset:1024 sc1
    buffer_load_dwordx4 v[40:43], v5, s[4:7], s21 offen offset:2048 sc1
    buffer_load_dwordx4 v[44:47], v5, s[4:7], s21 offen offset:3072 sc1
    s_add_u32 s21, s26, 8192
    buffer_load_dwordx4 v[48:51], v5, s[4:7], s21 offen offset:0 sc1
    buffer_load_dwordx4 v[52:55], v5, s[4:7], s21 offen offset:1024 sc1
    buffer_load_dwordx4 v[56:59], v5, s[4:7], s21 offen offset:2048 sc1
    buffer_load_dwordx4 v[60:63], v5, s[4:7], s21 offen offset:3072 sc1
    s_add_u32 s21, s26, 12288
    buffer_load_dwordx4 v[64:67], v5, s[4:7], s21 offen offset:0 sc1
    buffer_load_dwordx4 v[68:71], v5, s[4:7], s21 offen offset:1024 sc1
    v_mul_u32_u24 v0, 3584, v3
    v_lshl_add_u32 v0, v4, 4, v0
    buffer_load_dwordx4 v[144:147], v0, s[4:7], s27 offen offset:0 sc1
    buffer_load_dwordx4 v[148:151], v0, s[4:7], s27 offen offset:512 sc1
    buffer_load_dwordx4 v[152:155], v0, s[4:7], s27 offen offset:1024 sc1
    buffer_load_dwordx4 v[156:159], v0, s[4:7], s27 offen offset:1536 sc1
    buffer_load_dwordx4 v[160:163], v0, s[4:7], s27 offen offset:2048 sc1
    buffer_load_dwordx4 v[164:167], v0, s[4:7], s27 offen offset:2560 sc1
    buffer_load_dwordx4 v[168:171], v0, s[4:7], s27 offen offset:3072 sc1
    s_cmp_lg_u32 s15, 0
    s_cbranch_scc1 q1_22
    s_waitcnt vmcnt(21)
    s_branch q3_21
q2_20:
    s_cmp_lg_u32 s15, 0
    s_cbranch_scc1 qh_17
    s_waitcnt vmcnt(0)
q3_21:
    s_barrier
    s_cmp_ge_u32 s3, 4
    s_cbranch_scc1 qh_17
q1_22:
    ds_read_b128 v[72:75], v6 offset:0
    ds_read_b128 v[76:79], v6 offset:1024
    ds_read_b128 v[80:83], v6 offset:2048
    ds_read_b128 v[84:87], v6 offset:3072
    ds_read_b128 v[88:91], v6 offset:4096
    ds_read_b128 v[92:95], v6 offset:5120
    s_waitcnt vmcnt(20)
    s_waitcnt lgkmcnt(3)
    v_mfma_f32_32x32x16_bf16 v[96:111], v[72:75], v[16:19], 0
    v_mfma_f32_32x32x16_bf16 v[112:127], v[76:79], v[16:19], 0
    v_mfma_f32_32x32x16_bf16 v[128:143], v[16:19], v[80:83], 0
    s_add_u32 s21, s26, 12288
    buffer_load_dwordx4 v[16:19], v5, s[4:7], s21 offen offset:2048 sc1
    ds_read_b128 v[72:75], v6 offset:6144
    ds_read_b128 v[76:79], v6 offset:7168
    ds_read_b128 v[80:83], v6 offset:8192
    s_waitcnt vmcnt(20)
    s_waitcnt lgkmcnt(3)
    v_mfma_f32_32x32x16_bf16 v[96:111], v[84:87], v[20:23], v[96:111]
    v_lshlrev_b32 v11, 6, v3
    v_add_u32 v11, 151552, v11
    v_mfma_f32_32x32x16_bf16 v[112:127], v[88:91], v[20:23], v[112:127]
    ds_read_b128 v[176:179], v11 offset:0
    ds_read_b128 v[180:183], v11 offset:16
    v_mfma_f32_32x32x16_bf16 v[128:143], v[20:23], v[92:95], v[128:143]
    buffer_load_dwordx4 v[20:23], v5, s[4:7], s21 offen offset:3072 sc1
    ds_read_b128 v[184:187], v11 offset:32
    ds_read_b128 v[188:191], v11 offset:48
    ds_read_b128 v[84:87], v6 offset:9216
    ds_read_b128 v[88:91], v6 offset:10240
    ds_read_b128 v[92:95], v6 offset:11264
    s_waitcnt vmcnt(20)
    s_waitcnt lgkmcnt(7)
    v_mfma_f32_32x32x16_bf16 v[96:111], v[72:75], v[24:27], v[96:111]
    ds_read_b128 v[192:195], v11 offset:128
    ds_read_b128 v[196:199], v11 offset:144
    v_mfma_f32_32x32x16_bf16 v[112:127], v[76:79], v[24:27], v[112:127]
    ds_read_b128 v[200:203], v11 offset:160
    ds_read_b128 v[204:207], v11 offset:176
    v_mfma_f32_32x32x16_bf16 v[128:143], v[24:27], v[80:83], v[128:143]
    s_add_u32 s21, s26, 16384
    buffer_load_dwordx4 v[24:27], v5, s[4:7], s21 offen offset:0 sc1
    ds_read_b128 v[72:75], v6 offset:12288
    ds_read_b128 v[76:79], v6 offset:13312
    ds_read_b128 v[80:83], v6 offset:14336
    s_waitcnt vmcnt(20)
    s_waitcnt lgkmcnt(7)
    v_mfma_f32_32x32x16_bf16 v[96:111], v[84:87], v[28:31], v[96:111]
    v_lshlrev_b32 v10, 2, v4
    v_add_u32 v10, 151808, v10
    ds_read_b32 v208, v10
    v_mfma_f32_32x32x16_bf16 v[112:127], v[88:91], v[28:31], v[112:127]
    v_cmp_eq_u32 vcc, 28, v4
    v_mov_b32 v209, 0
    v_mov_b32 v210, 1.0
    v_mfma_f32_32x32x16_bf16 v[128:143], v[28:31], v[92:95], v[128:143]
    buffer_load_dwordx4 v[28:31], v5, s[4:7], s21 offen offset:1024 sc1
    s_nop 1
    v_cndmask_b32 v209, v209, v210, vcc
    ds_read_b128 v[84:87], v6 offset:15360
    ds_read_b128 v[88:91], v6 offset:16384
    ds_read_b128 v[92:95], v6 offset:17408
    s_waitcnt vmcnt(20)
    s_waitcnt lgkmcnt(4)
    v_mfma_f32_32x32x16_bf16 v[96:111], v[72:75], v[32:35], v[96:111]
    v_mfma_f32_32x32x16_bf16 v[112:127], v[76:79], v[32:35], v[112:127]
    v_mfma_f32_32x32x16_bf16 v[128:143], v[32:35], v[80:83], v[128:143]
    buffer_load_dwordx4 v[32:35], v5, s[4:7], s21 offen offset:2048 sc1
    ds_read_b128 v[72:75], v6 offset:18432
    ds_read_b128 v[76:79], v6 offset:19456
    ds_read_b128 v[80:83], v6 offset:20480
    s_waitcnt vmcnt(20)
    s_waitcnt lgkmcnt(3)
    v_mfma_f32_32x32x16_bf16 v[96:111], v[84:87], v[36:39], v[96:111]
    v_mfma_f32_32x32x16_bf16 v[112:127], v[88:91], v[36:39], v[112:127]
    v_mfma_f32_32x32x16_bf16 v[128:143], v[36:39], v[92:95], v[128:143]
    buffer_load_dwordx4 v[36:39], v5, s[4:7], s21 offen offset:3072 sc1
    ds_read_b128 v[84:87], v6 offset:21504
    ds_read_b128 v[88:91], v6 offset:22528
    ds_read_b128 v[92:95], v6 offset:23552
    s_waitcnt vmcnt(20)
    s_waitcnt lgkmcnt(3)
    v_mfma_f32_32x32x16_bf16 v[96:111], v[72:75], v[40:43], v[96:111]
    v_mfma_f32_32x32x16_bf16 v[112:127], v[76:79], v[40:43], v[112:127]
    v_mfma_f32_32x32x16_bf16 v[128:143], v[40:43], v[80:83], v[128:143]
    s_add_u32 s21, s26, 20480
    buffer_load_dwordx4 v[40:43], v5, s[4:7], s21 offen offset:0 sc1
    ds_read_b128 v[72:75], v6 offset:24576
    ds_read_b128 v[76:79], v6 offset:25600
    ds_read_b128 v[80:83], v6 offset:26624
    s_waitcnt vmcnt(20)
    s_waitcnt lgkmcnt(3)
    v_mfma_f32_32x32x16_bf16 v[96:111], v[84:87], v[44:47], v[96:111]
    v_mfma_f32_32x32x16_bf16 v[112:127], v[88:91], v[44:47], v[112:127]
    v_mfma_f32_32x32x16_bf16 v[128:143], v[44:47], v[92:95], v[128:143]
    buffer_load_dwordx4 v[44:47], v5, s[4:7], s21 offen offset:1024 sc1
    ds_read_b128 v[84:87], v6 offset:27648
    ds_read_b128 v[88:91], v6 offset:28672
    ds_read_b128 v[92:95], v6 offset:29696
    s_waitcnt vmcnt(20)
    s_waitcnt lgkmcnt(3)
    v_mfma_f32_32x32x16_bf16 v[96:111], v[72:75], v[48:51], v[96:111]
    v_mfma_f32_32x32x16_bf16 v[112:127], v[76:79], v[48:51], v[112:127]
    v_mfma_f32_32x32x16_bf16 v[128:143], v[48:51], v[80:83], v[128:143]
    buffer_load_dwordx4 v[48:51], v5, s[4:7], s21 offen offset:2048 sc1
    ds_read_b128 v[72:75], v6 offset:30720
    ds_read_b128 v[76:79], v6 offset:31744
    ds_read_b128 v[80:83], v6 offset:32768
    s_waitcnt vmcnt(20)
    s_waitcnt lgkmcnt(3)
    v_mfma_f32_32x32x16_bf16 v[96:111], v[84:87], v[52:55], v[96:111]
    v_mfma_f32_32x32x16_bf16 v[112:127], v[88:91], v[52:55], v[112:127]
    v_mfma_f32_32x32x16_bf16 v[128:143], v[52:55], v[92:95], v[128:143]
    buffer_load_dwordx4 v[52:55], v5, s[4:7], s21 offen offset:3072 sc1
    ds_read_b128 v[84:87], v6 offset:33792
    ds_read_b128 v[88:91], v6 offset:34816
    ds_read_b128 v[92:95], v6 offset:35840
    s_waitcnt vmcnt(20)
    s_waitcnt lgkmcnt(3)
    v_mfma_f32_32x32x16_bf16 v[96:111], v[72:75], v[56:59], v[96:111]
    v_mfma_f32_32x32x16_bf16 v[112:127], v[76:79], v[56:59], v[112:127]
    v_mfma_f32_32x32x16_bf16 v[128:143], v[56:59], v[80:83], v[128:143]
    s_add_u32 s21, s26, 24576
    buffer_load_dwordx4 v[56:59], v5, s[4:7], s21 offen offset:0 sc1
    ds_read_b128 v[72:75], v6 offset:36864
    ds_read_b128 v[76:79], v6 offset:37888
    ds_read_b128 v[80:83], v6 offset:38912
    s_waitcnt vmcnt(20)
    s_waitcnt lgkmcnt(3)
    v_mfma_f32_32x32x16_bf16 v[96:111], v[84:87], v[60:63], v[96:111]
    v_mfma_f32_32x32x16_bf16 v[112:127], v[88:91], v[60:63], v[112:127]
    v_mfma_f32_32x32x16_bf16 v[128:143], v[60:63], v[92:95], v[128:143]
    buffer_load_dwordx4 v[60:63], v5, s[4:7], s21 offen offset:1024 sc1
    ds_read_b128 v[84:87], v6 offset:39936
    ds_read_b128 v[88:91], v6 offset:40960
    ds_read_b128 v[92:95], v6 offset:41984
    s_waitcnt vmcnt(20)
    s_waitcnt lgkmcnt(3)
    v_mfma_f32_32x32x16_bf16 v[96:111], v[72:75], v[64:67], v[96:111]
    v_mfma_f32_32x32x16_bf16 v[112:127], v[76:79], v[64:67], v[112:127]
    v_mfma_f32_32x32x16_bf16 v[128:143], v[64:67], v[80:83], v[128:143]
    buffer_load_dwordx4 v[64:67], v5, s[4:7], s21 offen offset:2048 sc1
    ds_read_b128 v[72:75], v6 offset:43008
    ds_read_b128 v[76:79], v6 offset:44032
    ds_read_b128 v[80:83], v6 offset:45056
    s_waitcnt vmcnt(20)
    s_waitcnt lgkmcnt(3)
    v_mfma_f32_32x32x16_bf16 v[96:111], v[84:87], v[68:71], v[96:111]
    v_mfma_f32_32x32x16_bf16 v[112:127], v[88:91], v[68:71], v[112:127]
    v_mfma_f32_32x32x16_bf16 v[128:143], v[68:71], v[92:95], v[128:143]
    buffer_load_dwordx4 v[68:71], v5, s[4:7], s21 offen offset:3072 sc1
    ds_read_b128 v[84:87], v6 offset:46080
    ds_read_b128 v[88:91], v6 offset:47104
    ds_read_b128 v[92:95], v6 offset:48128
    s_waitcnt vmcnt(13)
    s_waitcnt lgkmcnt(3)
    v_mfma_f32_32x32x16_bf16 v[96:111], v[72:75], v[16:19], v[96:111]
    v_mfma_f32_32x32x16_bf16 v[112:127], v[76:79], v[16:19], v[112:127]
    v_mfma_f32_32x32x16_bf16 v[128:143], v[16:19], v[80:83], v[128:143]
    ds_read_b128 v[72:75], v6 offset:49152
    ds_read_b128 v[76:79], v6 offset:50176
    ds_read_b128 v[80:83], v6 offset:51200
    s_waitcnt vmcnt(12)
    s_waitcnt lgkmcnt(3)
    v_mfma_f32_32x32x16_bf16 v[96:111], v[84:87], v[20:23], v[96:111]
    v_add_f32 v144, v144, v148
    v_add_f32 v145, v145, v149
    v_add_f32 v146, v146, v150
    v_add_f32 v147, v147, v151
    v_mfma_f32_32x32x16_bf16 v[112:127], v[88:91], v[20:23], v[112:127]
    v_add_f32 v144, v144, v152
    v_add_f32 v145, v145, v153
    v_add_f32 v146, v146, v154
    v_add_f32 v147, v147, v155
    v_add_f32 v144, v144, v156
    v_mfma_f32_32x32x16_bf16 v[128:143], v[20:23], v[92:95], v[128:143]
    v_add_f32 v145, v145, v157
    v_add_f32 v146, v146, v158
    v_add_f32 v147, v147, v159
    v_add_f32 v144, v144, v160
    v_add_f32 v145, v145, v161
    ds_read_b128 v[84:87], v6 offset:52224
    ds_read_b128 v[88:91], v6 offset:53248
    ds_read_b128 v[92:95], v6 offset:54272
    s_waitcnt vmcnt(11)
    s_waitcnt lgkmcnt(3)
    v_mfma_f32_32x32x16_bf16 v[96:111], v[72:75], v[24:27], v[96:111]
    v_add_f32 v146, v146, v162
    v_add_f32 v147, v147, v163
    v_add_f32 v144, v144, v164
    v_add_f32 v145, v145, v165
    v_mfma_f32_32x32x16_bf16 v[112:127], v[76:79], v[24:27], v[112:127]
    v_add_f32 v146, v146, v166
    v_add_f32 v147, v147, v167
    v_add_f32 v144, v144, v168
    v_add_f32 v145, v145, v169
    v_mfma_f32_32x32x16_bf16 v[128:143], v[24:27], v[80:83], v[128:143]
    v_add_f32 v146, v146, v170
    v_add_f32 v147, v147, v171
    v_add_f32 v144, v144, v146
    v_add_f32 v145, v145, v147
    ds_read_b128 v[72:75], v6 offset:55296
    ds_read_b128 v[76:79], v6 offset:56320
    ds_read_b128 v[80:83], v6 offset:57344
    s_waitcnt vmcnt(10)
    s_waitcnt lgkmcnt(3)
    v_mfma_f32_32x32x16_bf16 v[96:111], v[84:87], v[28:31], v[96:111]
    v_mov_b32 v10, v144
    s_nop 1
    v_permlane32_swap_b32 v144, v10
    s_nop 0
    v_mfma_f32_32x32x16_bf16 v[112:127], v[88:91], v[28:31], v[112:127]
    v_add_f32 v144, v144, v10
    v_mov_b32 v10, v145
    s_nop 1
    v_permlane32_swap_b32 v145, v10
    v_mfma_f32_32x32x16_bf16 v[128:143], v[28:31], v[92:95], v[128:143]
    s_nop 0
    v_add_f32 v145, v145, v10
    v_mul_f32 v144, 0x3b124925, v144
    ds_read_b128 v[84:87], v6 offset:58368
    ds_read_b128 v[88:91], v6 offset:59392
    ds_read_b128 v[92:95], v6 offset:60416
    s_waitcnt vmcnt(9)
    s_waitcnt lgkmcnt(3)
    v_mfma_f32_32x32x16_bf16 v[96:111], v[72:75], v[32:35], v[96:111]
    v_mul_f32 v145, 0x3b124925, v145
    v_fma_f32 v145, -v144, v144, v145
    v_max_f32 v145, 0, v145
    v_mfma_f32_32x32x16_bf16 v[112:127], v[76:79], v[32:35], v[112:127]
    v_add_f32 v145, 0x3727c5ac, v145
    v_rsq_f32 v8, v145
    s_nop 0
    v_mfma_f32_32x32x16_bf16 v[128:143], v[32:35], v[80:83], v[128:143]
    v_mul_f32 v9, v144, v8
    v_sub_f32 v9, 0, v9
    ds_read_b128 v[72:75], v6 offset:61440
    ds_read_b128 v[76:79], v6 offset:62464
    ds_read_b128 v[80:83], v6 offset:63488
    s_waitcnt vmcnt(8)
    s_waitcnt lgkmcnt(3)
    v_mfma_f32_32x32x16_bf16 v[96:111], v[84:87], v[36:39], v[96:111]
    s_lshl_b32 s28, s3, 8
    s_add_u32 s28, s28, 152064
    v_lshlrev_b32 v10, 3, v4
    v_mfma_f32_32x32x16_bf16 v[112:127], v[88:91], v[36:39], v[112:127]
    v_add_u32 v10, s28, v10
    ds_write_b64 v10, v[8:9]
    v_mul_f32 v14, 0x3e8b97f6, v8
    v_mfma_f32_32x32x16_bf16 v[128:143], v[36:39], v[92:95], v[128:143]
    v_mul_f32 v15, 0x3e8b97f6, v9
    v_lshlrev_b32 v11, 5, v3
    v_add_u32 v11, s28, v11
    ds_read_b128 v[84:87], v6 offset:64512
    ds_read_b128 v[88:91], v7 offset:0
    ds_read_b128 v[92:95], v7 offset:1024
    s_waitcnt vmcnt(7)
    s_waitcnt lgkmcnt(4)
    v_mfma_f32_32x32x16_bf16 v[96:111], v[72:75], v[40:43], v[96:111]
    s_waitcnt lgkmcnt(3)
    ds_read_b128 v[212:215], v11 offset:0
    ds_read_b128 v[216:219], v11 offset:16
    v_mfma_f32_32x32x16_bf16 v[112:127], v[76:79], v[40:43], v[112:127]
    ds_read_b128 v[220:223], v11 offset:64
    ds_read_b128 v[224:227], v11 offset:80
    ds_read_b128 v[228:231], v11 offset:128
    v_mfma_f32_32x32x16_bf16 v[128:143], v[40:43], v[80:83], v[128:143]
    ds_read_b128 v[232:235], v11 offset:144
    ds_read_b128 v[236:239], v11 offset:192
    ds_read_b128 v[240:243], v11 offset:208
    ds_read_b128 v[72:75], v7 offset:2048
    ds_read_b128 v[76:79], v7 offset:3072
    ds_read_b128 v[80:83], v7 offset:4096
    s_waitcnt vmcnt(6)
    s_waitcnt lgkmcnt(11)
    v_mfma_f32_32x32x16_bf16 v[96:111], v[84:87], v[44:47], v[96:111]
    v_mul_f32 v176, v15, v176
    v_mul_f32 v177, v15, v177
    v_mul_f32 v178, v15, v178
    v_mul_f32 v179, v15, v179
    v_mul_f32 v180, v15, v180
    v_mul_f32 v181, v15, v181
    v_mfma_f32_32x32x16_bf16 v[112:127], v[88:91], v[44:47], v[112:127]
    v_mul_f32 v182, v15, v182
    v_mul_f32 v183, v15, v183
    v_mul_f32 v184, v15, v184
    v_mul_f32 v185, v15, v185
    v_mul_f32 v186, v15, v186
    v_mul_f32 v187, v15, v187
    v_mfma_f32_32x32x16_bf16 v[128:143], v[44:47], v[92:95], v[128:143]
    v_mul_f32 v188, v15, v188
    v_mul_f32 v189, v15, v189
    v_mul_f32 v190, v15, v190
    v_mul_f32 v191, v15, v191
    ds_read_b128 v[84:87], v7 offset:5120
    ds_read_b128 v[88:91], v7 offset:6144
    ds_read_b128 v[92:95], v7 offset:7168
    s_waitcnt vmcnt(5)
    s_waitcnt lgkmcnt(3)
    v_mfma_f32_32x32x16_bf16 v[96:111], v[72:75], v[48:51], v[96:111]
    v_mul_f32 v192, v9, v192
    v_mul_f32 v193, v9, v193
    v_mul_f32 v194, v9, v194
    v_mul_f32 v195, v9, v195
    v_mul_f32 v196, v9, v196
    v_mul_f32 v197, v9, v197
    v_mfma_f32_32x32x16_bf16 v[112:127], v[76:79], v[48:51], v[112:127]
    v_mul_f32 v198, v9, v198
    v_mul_f32 v199, v9, v199
    v_mul_f32 v200, v9, v200
    v_mul_f32 v201, v9, v201
    v_mul_f32 v202, v9, v202
    v_mul_f32 v203, v9, v203
    v_mfma_f32_32x32x16_bf16 v[128:143], v[48:51], v[80:83], v[128:143]
    v_mul_f32 v204, v9, v204
    v_mul_f32 v205, v9, v205
    v_mul_f32 v206, v9, v206
    v_mul_f32 v207, v9, v207
    ds_read_b128 v[72:75], v7 offset:8192
    ds_read_b128 v[76:79], v7 offset:9216
    ds_read_b128 v[80:83], v7 offset:10240
    s_waitcnt vmcnt(4)
    s_waitcnt lgkmcnt(3)
    v_mfma_f32_32x32x16_bf16 v[96:111], v[84:87], v[52:55], v[96:111]
    v_mfma_f32_32x32x16_bf16 v[112:127], v[88:91], v[52:55], v[112:127]
    v_mfma_f32_32x32x16_bf16 v[128:143], v[52:55], v[92:95], v[128:143]
    ds_read_b128 v[84:87], v7 offset:11264
    ds_read_b128 v[88:91], v7 offset:12288
    ds_read_b128 v[92:95], v7 offset:13312
    s_waitcnt vmcnt(3)
    s_waitcnt lgkmcnt(3)
    v_mfma_f32_32x32x16_bf16 v[96:111], v[72:75], v[56:59], v[96:111]
    v_fma_f32 v213, v213, v208, v209
    v_fma_f32 v215, v215, v208, v209
    v_fma_f32 v217, v217, v208, v209
    v_mfma_f32_32x32x16_bf16 v[112:127], v[76:79], v[56:59], v[112:127]
    v_fma_f32 v219, v219, v208, v209
    v_fma_f32 v221, v221, v208, v209
    v_fma_f32 v223, v223, v208, v209
    v_mfma_f32_32x32x16_bf16 v[128:143], v[56:59], v[80:83], v[128:143]
    v_fma_f32 v225, v225, v208, v209
    v_fma_f32 v227, v227, v208, v209
    ds_read_b128 v[72:75], v7 offset:14336
    ds_read_b128 v[76:79], v7 offset:15360
    ds_read_b128 v[80:83], v7 offset:16384
    s_waitcnt vmcnt(2)
    s_waitcnt lgkmcnt(3)
    v_mfma_f32_32x32x16_bf16 v[96:111], v[84:87], v[60:63], v[96:111]
    v_fma_f32 v229, v229, v208, v209
    v_fma_f32 v231, v231, v208, v209
    v_fma_f32 v233, v233, v208, v209
    v_mfma_f32_32x32x16_bf16 v[112:127], v[88:91], v[60:63], v[112:127]
    v_fma_f32 v235, v235, v208, v209
    v_fma_f32 v237, v237, v208, v209
    v_fma_f32 v239, v239, v208, v209
    v_mfma_f32_32x32x16_bf16 v[128:143], v[60:63], v[92:95], v[128:143]
    v_fma_f32 v241, v241, v208, v209
    v_fma_f32 v243, v243, v208, v209
    ds_read_b128 v[84:87], v7 offset:17408
    ds_read_b128 v[88:91], v7 offset:18432
    ds_read_b128 v[92:95], v7 offset:19456
    s_waitcnt vmcnt(1)
    s_waitcnt lgkmcnt(3)
    v_mfma_f32_32x32x16_bf16 v[96:111], v[72:75], v[64:67], v[96:111]
    s_lshl_b32 s29, s23, 6
    s_add_u32 s29, s29, s25
    s_lshl_b32 s30, s29, 11
    s_add_u32 s30, s30, s14
    s_add_u32 s30, s30, 0x1480000
    s_lshl_b32 s31, s29, 12
    v_mfma_f32_32x32x16_bf16 v[112:127], v[76:79], v[64:67], v[112:127]
    s_add_u32 s31, s31, s47
    s_add_u32 s31, s31, 0x1880000
    s_lshl_b32 s32, s29, 2
    s_lshr_b32 s33, s47, 10
    s_add_u32 s32, s32, s33
    s_add_u32 s32, s32, 0x12a0000
    v_mfma_f32_32x32x16_bf16 v[128:143], v[64:67], v[80:83], v[128:143]
    v_mov_b32 v12, 0
    v_mov_b32 v13, 0
    v_mov_b32 v10, 0
    v_mov_b32 v11, 0
    s_waitcnt vmcnt(0)
    s_waitcnt lgkmcnt(0)
    v_mfma_f32_32x32x16_bf16 v[96:111], v[84:87], v[68:71], v[96:111]
    v_mfma_f32_32x32x16_bf16 v[112:127], v[88:91], v[68:71], v[112:127]
    v_mfma_f32_32x32x16_bf16 v[128:143], v[68:71], v[92:95], v[128:143]
    s_nop 13
    v_fma_f32 v112, v8, v112, v192
    v_fma_f32 v113, v8, v113, v193
    v_fma_f32 v114, v8, v114, v194
    v_fma_f32 v115, v8, v115, v195
    v_fma_f32 v116, v8, v116, v196
    v_fma_f32 v117, v8, v117, v197
    v_fma_f32 v118, v8, v118, v198
    v_fma_f32 v119, v8, v119, v199
    v_fma_f32 v120, v8, v120, v200
    v_fma_f32 v121, v8, v121, v201
    v_fma_f32 v122, v8, v122, v202
    v_fma_f32 v123, v8, v123, v203
    v_fma_f32 v124, v8, v124, v204
    v_fma_f32 v125, v8, v125, v205
    v_fma_f32 v126, v8, v126, v206
    v_fma_f32 v127, v8, v127, v207
    v_fma_f32 v128, v212, v128, v213
    v_fma_f32 v129, v214, v129, v215
    v_fma_f32 v130, v216, v130, v217
    v_fma_f32 v131, v218, v131, v219
    v_fma_f32 v132, v220, v132, v221
    v_fma_f32 v133, v222, v133, v223
    v_fma_f32 v134, v224, v134, v225
    v_fma_f32 v135, v226, v135, v227
    v_fma_f32 v136, v228, v136, v229
    v_fma_f32 v137, v230, v137, v231
    v_fma_f32 v138, v232, v138, v233
    v_fma_f32 v139, v234, v139, v235
    v_fma_f32 v140, v236, v140, v237
    v_fma_f32 v141, v238, v141, v239
    v_fma_f32 v142, v240, v142, v241
    v_fma_f32 v143, v242, v143, v243
    v_cvt_pk_bf16_f32 v32, v128, v129
    v_cvt_pk_bf16_f32 v33, v130, v131
    v_cvt_pk_bf16_f32 v34, v132, v133
    v_cvt_pk_bf16_f32 v35, v134, v135
    v_cvt_pk_bf16_f32 v36, v136, v137
    v_cvt_pk_bf16_f32 v37, v138, v139
    v_cvt_pk_bf16_f32 v38, v140, v141
    v_cvt_pk_bf16_f32 v39, v142, v143
    v_fmac_f32 v13, v112, v112
    v_fmac_f32 v11, v113, v113
    v_fmac_f32 v13, v114, v114
    v_fmac_f32 v11, v115, v115
    buffer_store_dwordx4 v[32:35], v5, s[4:7], s31 offen offset:2048 sc1
    buffer_store_dwordx4 v[36:39], v5, s[4:7], s31 offen offset:3072 sc1
    v_fmac_f32 v13, v116, v116
    v_fmac_f32 v11, v117, v117
    v_fmac_f32 v13, v118, v118
    v_fmac_f32 v11, v119, v119
    v_fmac_f32 v13, v120, v120
    v_fmac_f32 v11, v121, v121
    v_fmac_f32 v13, v122, v122
    v_fmac_f32 v11, v123, v123
    v_fmac_f32 v13, v124, v124
    v_fmac_f32 v11, v125, v125
    v_fmac_f32 v13, v126, v126
    v_fmac_f32 v11, v127, v127
    s_mov_b32 exec_lo, 0
    v_mov_b32 v124, 1.0
    v_mov_b32 v125, 1.0
    s_mov_b32 exec_lo, -1
    v_cvt_pk_bf16_f32 v24, v112, v113
    v_cvt_pk_bf16_f32 v25, v114, v115
    v_cvt_pk_bf16_f32 v26, v116, v117
    v_cvt_pk_bf16_f32 v27, v118, v119
    v_cvt_pk_bf16_f32 v28, v120, v121
    v_cvt_pk_bf16_f32 v29, v122, v123
    v_cvt_pk_bf16_f32 v30, v124, v125
    v_cvt_pk_bf16_f32 v31, v126, v127
    v_fma_f32 v96, v14, v96, v176
    v_fma_f32 v97, v14, v97, v177
    v_fma_f32 v98, v14, v98, v178
    buffer_store_dwordx4 v[24:27], v5, s[4:7], s31 offen offset:0 sc1
    buffer_store_dwordx4 v[28:31], v5, s[4:7], s31 offen offset:1024 sc1
    v_fma_f32 v99, v14, v99, v179
    v_fma_f32 v100, v14, v100, v180
    v_fma_f32 v101, v14, v101, v181
    v_fma_f32 v102, v14, v102, v182
    v_fma_f32 v103, v14, v103, v183
    v_fma_f32 v104, v14, v104, v184
    v_fma_f32 v105, v14, v105, v185
    v_fma_f32 v106, v14, v106, v186
    v_fma_f32 v107, v14, v107, v187
    v_fma_f32 v108, v14, v108, v188
    v_fma_f32 v109, v14, v109, v189
    v_fma_f32 v110, v14, v110, v190
    v_fma_f32 v111, v14, v111, v191
    v_fmac_f32 v12, v96, v96
    v_fmac_f32 v10, v97, v97
    v_fmac_f32 v12, v98, v98
    v_fmac_f32 v10, v99, v99
    v_fmac_f32 v12, v100, v100
    v_fmac_f32 v10, v101, v101
    v_fmac_f32 v12, v102, v102
    v_fmac_f32 v10, v103, v103
    v_fmac_f32 v12, v104, v104
    v_fmac_f32 v10, v105, v105
    v_fmac_f32 v12, v106, v106
    v_fmac_f32 v10, v107, v107
    v_fmac_f32 v12, v108, v108
    v_fmac_f32 v10, v109, v109
    v_fmac_f32 v12, v110, v110
    v_fmac_f32 v10, v111, v111
    v_add_f32 v12, v12, v10
    v_add_f32 v13, v13, v11
    v_mov_b32 v10, v12
    v_mov_b32 v11, v13
    v_cvt_pk_bf16_f32 v16, v96, v97
    v_cvt_pk_bf16_f32 v17, v98, v99
    v_cvt_pk_bf16_f32 v18, v100, v101
    v_cvt_pk_bf16_f32 v19, v102, v103
    v_permlane32_swap_b32 v12, v10
    v_permlane32_swap_b32 v13, v11
    buffer_store_dwordx4 v[16:19], v5, s[4:7], s30 offen sc1
    s_nop 0
    v_add_f32 v12, v12, v10
    v_add_f32 v13, v13, v11
    v_sqrt_f32 v12, v12
    v_cvt_pk_bf16_f32 v20, v104, v105
    v_cvt_pk_bf16_f32 v21, v106, v107
    v_cvt_pk_bf16_f32 v22, v108, v109
    s_mov_b32 exec_lo, 0
    v_mov_b32 v110, v12
    s_mov_b32 exec_lo, -1
    v_cvt_pk_bf16_f32 v23, v110, v111
    s_nop 0
    buffer_store_dwordx4 v[20:23], v5, s[4:7], s30 offen offset:1024 sc1
    s_nop 1
    v_max_f32_dpp v13, v13, v13 row_shr:1 row_mask:0xf bank_mask:0xf
    s_nop 1
    v_max_f32_dpp v13, v13, v13 row_shr:2 row_mask:0xf bank_mask:0xf
    s_nop 1
    v_max_f32_dpp v13, v13, v13 row_shr:4 row_mask:0xf bank_mask:0xf
    s_nop 1
    v_max_f32_dpp v13, v13, v13 row_shr:8 row_mask:0xf bank_mask:0xf
    s_nop 1
    v_max_f32_dpp v13, v13, v13 row_bcast:15 row_mask:0xa bank_mask:0xf
    s_nop 1
    v_max_f32_dpp v13, v13, v13 row_bcast:31 row_mask:0xc bank_mask:0xf
    s_mov_b32 exec_lo, 0
    s_mov_b32 exec_hi, 0x80000000
    buffer_store_dword v13, off, s[4:7], s32 sc1
    s_mov_b32 exec_lo, -1
    s_mov_b32 exec_hi, -1
    s_branch qe_18
qh_17:
qe_18:
    s_lshl_b32 s24, s23, 7
    s_lshl_b32 s25, s22, 2
    s_add_u32 s24, s24, s25
    s_add_u32 s24, s24, s16
    s_cmp_ge_u32 s3, 4
    s_cbranch_scc1 ph_27
    s_waitcnt vmcnt(0)
ph_27:
    s_barrier
    s_cmp_lg_u32 s3, 0
    s_cbranch_scc1 pb_28
    s_mov_b32 exec_lo, 1
    s_mov_b32 exec_hi, 0
    v_mov_b32 v9, 1
    buffer_store_dword v9, off, s[4:7], s24 sc1
    s_mov_b32 exec_lo, -1
    s_mov_b32 exec_hi, -1
pb_28:
    s_and_b32 s20, s13, 1
    s_lshl_b32 s22, s12, 1
    s_add_u32 s22, s22, s20
    s_lshr_b32 s21, s13, 1
    s_lshl_b32 s24, s22, 7
    s_add_u32 s24, s24, s16
    s_cmp_lg_u32 s3, 0
    s_cbranch_scc1 pl_30
    s_mov_b32 exec_lo, 0xffff
    s_mov_b32 exec_hi, 0
    v_lshlrev_b32 v8, 2, v1
    s_mov_b32 s18, 0
    buffer_load_dword v32, v8, s[4:7], s24 offen sc1
    s_sleep 1
    buffer_load_dword v33, v8, s[4:7], s24 offen sc1
    s_sleep 1
    buffer_load_dword v34, v8, s[4:7], s24 offen sc1
pl_29:
    s_waitcnt vmcnt(2)
    v_cmp_eq_u32 vcc, 0, v32
    s_add_u32 s18, s18, 1
    s_nop 0
    s_cmp_eq_u32 vcc_lo, 0
    s_cbranch_scc1 pl_31
    buffer_load_dword v32, v8, s[4:7], s24 offen sc1
    s_waitcnt vmcnt(2)
    v_cmp_eq_u32 vcc, 0, v33
    s_add_u32 s18, s18, 1
    s_nop 0
    s_cmp_eq_u32 vcc_lo, 0
    s_cbranch_scc1 pl_31
    buffer_load_dword v33, v8, s[4:7], s24 offen sc1
    s_waitcnt vmcnt(2)
    v_cmp_eq_u32 vcc, 0, v34
    s_add_u32 s18, s18, 1
    s_nop 0
    s_cmp_eq_u32 vcc_lo, 0
    s_cbranch_scc1 pl_31
    buffer_load_dword v34, v8, s[4:7], s24 offen sc1
    s_cmp_lt_u32 s18, 32768
    s_cbranch_scc1 pl_29
pl_31:
    s_mov_b32 exec_lo, -1
    s_mov_b32 exec_hi, -1
pl_30:
    s_barrier
    s_and_b32 s23, s3, 1
    s_lshr_b32 s24, s3, 1
    s_lshl_b32 s25, s21, 2
    s_lshl_b32 s26, s23, 1
    s_add_u32 s25, s25, s26
    s_lshl_b32 s27, s22, 6
    s_add_u32 s28, s27, s25
    s_lshl_b32 s28, s28, 11
    s_add_u32 s28, s28, s14
    s_add_u32 s28, s28, 0x1480000
    s_lshl_b32 s29, s24, 4
    s_add_u32 s29, s29, s27
    s_lshl_b32 s29, s29, 12
    s_add_u32 s29, s29, s47
    s_add_u32 s29, s29, 0x1880000
    s_lshl_b32 s30, s27, 2
    s_lshr_b32 s33, s47, 10
    s_add_u32 s30, s30, s33
    s_add_u32 s30, s30, 0x12a0000
    v_lshlrev_b32 v0, 2, v1
    s_lshl_b32 s18, s12, 7
    s_add_u32 s18, s18, 16005120
    v_lshlrev_b32 v8, 2, v4
    buffer_load_dword v12, v8, s[4:7], s18 offen sc1
    buffer_load_dword v11, v0, s[4:7], s30 offen sc1
    buffer_load_dwordx4 v[16:19], v5, s[4:7], s28 offen offset:0 sc1
    buffer_load_dwordx4 v[20:23], v5, s[4:7], s28 offen offset:1024 sc1
    buffer_load_dwordx4 v[24:27], v5, s[4:7], s28 offen offset:2048 sc1
    buffer_load_dwordx4 v[28:31], v5, s[4:7], s28 offen offset:3072 sc1
    v_mov_b32 v8, 0
    v_mov_b32 v9, 159744
    ds_write_b32 v9, v8
    s_mov_b32 s40, 0
    s_add_u32 s31, s29, 0
    buffer_load_dwordx4 v[32:35], v5, s[4:7], s31 offen offset:0
    buffer_load_dwordx4 v[36:39], v5, s[4:7], s31 offen offset:1024
    s_barrier
    s_add_u32 s31, s29, 0
    buffer_load_dwordx4 v[40:43], v5, s[4:7], s31 offen offset:2048
    buffer_load_dwordx4 v[44:47], v5, s[4:7], s31 offen offset:3072
    s_add_u32 s31, s29, 4096
    buffer_load_dwordx4 v[48:51], v5, s[4:7], s31 offen offset:0
    buffer_load_dwordx4 v[52:55], v5, s[4:7], s31 offen offset:1024
    buffer_load_dwordx4 v[56:59], v5, s[4:7], s31 offen offset:2048
    buffer_load_dwordx4 v[60:63], v5, s[4:7], s31 offen offset:3072
    s_add_u32 s31, s29, 8192
    buffer_load_dwordx4 v[64:67], v5, s[4:7], s31 offen offset:0
    buffer_load_dwordx4 v[68:71], v5, s[4:7], s31 offen offset:1024
    buffer_load_dwordx4 v[72:75], v5, s[4:7], s31 offen offset:2048
    buffer_load_dwordx4 v[76:79], v5, s[4:7], s31 offen offset:3072
    s_add_u32 s31, s29, 12288
    buffer_load_dwordx4 v[80:83], v5, s[4:7], s31 offen offset:0
    buffer_load_dwordx4 v[84:87], v5, s[4:7], s31 offen offset:1024
    buffer_load_dwordx4 v[88:91], v5, s[4:7], s31 offen offset:2048
    buffer_load_dwordx4 v[92:95], v5, s[4:7], s31 offen offset:3072
    s_waitcnt vmcnt(20)
    v_cmp_ne_u32 vcc, s46, v12
    s_nop 1
    s_or_b32 s18, vcc_lo, vcc_hi
    s_cmp_eq_u32 s18, 0
    s_cselect_b32 s17, 1, 0
    s_and_b32 s48, s17, s15
    s_nop 1
    v_max_f32_dpp v11, v11, v11 row_shr:1 row_mask:0xf bank_mask:0xf
    s_nop 1
    v_max_f32_dpp v11, v11, v11 row_shr:2 row_mask:0xf bank_mask:0xf
    s_nop 1
    v_max_f32_dpp v11, v11, v11 row_shr:4 row_mask:0xf bank_mask:0xf
    s_nop 1
    v_max_f32_dpp v11, v11, v11 row_shr:8 row_mask:0xf bank_mask:0xf
    s_nop 1
    v_max_f32_dpp v11, v11, v11 row_bcast:15 row_mask:0xa bank_mask:0xf
    s_nop 1
    v_max_f32_dpp v11, v11, v11 row_bcast:31 row_mask:0xc bank_mask:0xf
    s_nop 0
    v_readlane_b32 s32, v11, 63
    s_nop 1
    v_sqrt_f32 v11, s32
    s_nop 0
    v_mul_f32 v11, 0x3f820000, v11
    s_waitcnt vmcnt(16)
    v_lshlrev_b32 v14, 16, v23
    v_mul_f32 v14, v14, v11
    v_cvt_pk_bf16_f32 v8, v14, v14
    v_and_b32 v8, 0xffff0000, v8
    v_sub_f32 v9, v14, v8
    v_cvt_pk_bf16_f32 v10, v9, v9
    v_and_b32 v10, 0xffff0000, v10
    v_add_f32 v14, v8, v10
    v_cvt_pk_bf16_f32 v9, -v8, -v10
    s_mov_b32 exec_lo, 0
    v_mov_b32 v22, v9
    s_mov_b32 exec_lo, -1
    v_lshlrev_b32 v15, 16, v31
    v_mul_f32 v15, v15, v11
    v_cvt_pk_bf16_f32 v8, v15, v15
    v_and_b32 v8, 0xffff0000, v8
    v_sub_f32 v9, v15, v8
    v_cvt_pk_bf16_f32 v10, v9, v9
    v_and_b32 v10, 0xffff0000, v10
    v_add_f32 v15, v8, v10
    v_cvt_pk_bf16_f32 v9, -v8, -v10
    s_mov_b32 exec_lo, 0
    v_mov_b32 v30, v9
    s_mov_b32 exec_lo, -1
main_32:
    s_waitcnt vmcnt(14)
    s_nop 1
    v_mfma_f32_32x32x16_bf16 v[96:111], v[32:35], v[16:19], 0
    v_mfma_f32_32x32x16_bf16 v[96:111], v[36:39], v[20:23], v[96:111]
    s_nop 15
    s_setprio 3
    v_mfma_f32_32x32x16_bf16 v[112:127], v[32:35], v[24:27], 0
    v_exp_f32 v96, v96
    v_exp_f32 v97, v97
    v_exp_f32 v98, v98
    v_exp_f32 v99, v99
    v_exp_f32 v100, v100
    v_exp_f32 v101, v101
    v_mfma_f32_32x32x16_bf16 v[112:127], v[36:39], v[28:31], v[112:127]
    v_exp_f32 v102, v102
    v_exp_f32 v103, v103
    v_exp_f32 v104, v104
    v_exp_f32 v105, v105
    v_exp_f32 v106, v106
    v_exp_f32 v107, v107
    v_exp_f32 v108, v108
    v_exp_f32 v109, v109
    v_exp_f32 v110, v110
    v_exp_f32 v111, v111
    v_cvt_pk_bf16_f32 v128, v96, v97
    v_cvt_pk_bf16_f32 v129, v98, v99
    v_cvt_pk_bf16_f32 v130, v100, v101
    v_cvt_pk_bf16_f32 v131, v102, v103
    v_cvt_pk_bf16_f32 v132, v104, v105
    v_cvt_pk_bf16_f32 v133, v106, v107
    v_cvt_pk_bf16_f32 v134, v108, v109
    v_cvt_pk_bf16_f32 v135, v110, v111
    s_waitcnt vmcnt(10)
    v_mfma_f32_32x32x16_bf16 v[96:111], v[48:51], v[16:19], 0
    v_exp_f32 v112, v112
    v_exp_f32 v113, v113
    v_exp_f32 v114, v114
    v_exp_f32 v115, v115
    v_exp_f32 v116, v116
    v_exp_f32 v117, v117
    v_mfma_f32_32x32x16_bf16 v[96:111], v[52:55], v[20:23], v[96:111]
    v_exp_f32 v118, v118
    v_exp_f32 v119, v119
    v_exp_f32 v120, v120
    v_exp_f32 v121, v121
    v_exp_f32 v122, v122
    v_exp_f32 v123, v123
    v_mfma_f32_32x32x16_bf16 v[144:159], v[40:43], v[128:131], 0
    v_exp_f32 v124, v124
    v_exp_f32 v125, v125
    v_exp_f32 v126, v126
    v_exp_f32 v127, v127
    v_cvt_pk_bf16_f32 v136, v112, v113
    v_cvt_pk_bf16_f32 v137, v114, v115
    v_mfma_f32_32x32x16_bf16 v[144:159], v[44:47], v[132:135], v[144:159]
    v_cvt_pk_bf16_f32 v138, v116, v117
    v_cvt_pk_bf16_f32 v139, v118, v119
    v_cvt_pk_bf16_f32 v140, v120, v121
    v_cvt_pk_bf16_f32 v141, v122, v123
    v_cvt_pk_bf16_f32 v142, v124, v125
    v_cvt_pk_bf16_f32 v143, v126, v127
    v_mfma_f32_32x32x16_bf16 v[112:127], v[48:51], v[24:27], 0
    v_exp_f32 v96, v96
    v_exp_f32 v97, v97
    v_exp_f32 v98, v98
    v_exp_f32 v99, v99
    v_exp_f32 v100, v100
    v_exp_f32 v101, v101
    v_mfma_f32_32x32x16_bf16 v[112:127], v[52:55], v[28:31], v[112:127]
    v_exp_f32 v102, v102
    v_exp_f32 v103, v103
    v_exp_f32 v104, v104
    v_exp_f32 v105, v105
    v_exp_f32 v106, v106
    v_exp_f32 v107, v107
    v_mfma_f32_32x32x16_bf16 v[160:175], v[40:43], v[136:139], 0
    v_exp_f32 v108, v108
    v_exp_f32 v109, v109
    v_exp_f32 v110, v110
    v_exp_f32 v111, v111
    v_cvt_pk_bf16_f32 v128, v96, v97
    v_cvt_pk_bf16_f32 v129, v98, v99
    v_mfma_f32_32x32x16_bf16 v[160:175], v[44:47], v[140:143], v[160:175]
    v_cvt_pk_bf16_f32 v130, v100, v101
    v_cvt_pk_bf16_f32 v131, v102, v103
    v_cvt_pk_bf16_f32 v132, v104, v105
    v_cvt_pk_bf16_f32 v133, v106, v107
    v_cvt_pk_bf16_f32 v134, v108, v109
    v_cvt_pk_bf16_f32 v135, v110, v111
    s_add_u32 s31, s29, 16384
    buffer_load_dwordx4 v[32:35], v5, s[4:7], s31 offen offset:0
    buffer_load_dwordx4 v[36:39], v5, s[4:7], s31 offen offset:1024
    buffer_load_dwordx4 v[40:43], v5, s[4:7], s31 offen offset:2048
    buffer_load_dwordx4 v[44:47], v5, s[4:7], s31 offen offset:3072
    s_add_u32 s55, s54, 0
    buffer_load_dwordx4 v[176:179], v5, s[4:7], s55 offen offset:0
    s_waitcnt vmcnt(11)
    v_mfma_f32_32x32x16_bf16 v[96:111], v[64:67], v[16:19], 0
    v_exp_f32 v112, v112
    v_exp_f32 v113, v113
    v_exp_f32 v114, v114
    v_exp_f32 v115, v115
    v_exp_f32 v116, v116
    v_exp_f32 v117, v117
    v_mfma_f32_32x32x16_bf16 v[96:111], v[68:71], v[20:23], v[96:111]
    v_exp_f32 v118, v118
    v_exp_f32 v119, v119
    v_exp_f32 v120, v120
    v_exp_f32 v121, v121
    v_exp_f32 v122, v122
    v_exp_f32 v123, v123
    v_mfma_f32_32x32x16_bf16 v[144:159], v[56:59], v[128:131], v[144:159]
    v_exp_f32 v124, v124
    v_exp_f32 v125, v125
    v_exp_f32 v126, v126
    v_exp_f32 v127, v127
    v_cvt_pk_bf16_f32 v136, v112, v113
    v_cvt_pk_bf16_f32 v137, v114, v115
    v_mfma_f32_32x32x16_bf16 v[144:159], v[60:63], v[132:135], v[144:159]
    v_cvt_pk_bf16_f32 v138, v116, v117
    v_cvt_pk_bf16_f32 v139, v118, v119
    v_cvt_pk_bf16_f32 v140, v120, v121
    v_cvt_pk_bf16_f32 v141, v122, v123
    v_cvt_pk_bf16_f32 v142, v124, v125
    v_cvt_pk_bf16_f32 v143, v126, v127
    s_add_u32 s55, s54, 0
    buffer_load_dwordx4 v[180:183], v5, s[4:7], s55 offen offset:1024
    v_mfma_f32_32x32x16_bf16 v[112:127], v[64:67], v[24:27], 0
    v_exp_f32 v96, v96
    v_exp_f32 v97, v97
    v_exp_f32 v98, v98
    v_exp_f32 v99, v99
    v_exp_f32 v100, v100
    v_exp_f32 v101, v101
    v_mfma_f32_32x32x16_bf16 v[112:127], v[68:71], v[28:31], v[112:127]
    v_exp_f32 v102, v102
    v_exp_f32 v103, v103
    v_exp_f32 v104, v104
    v_exp_f32 v105, v105
    v_exp_f32 v106, v106
    v_exp_f32 v107, v107
    v_mfma_f32_32x32x16_bf16 v[160:175], v[56:59], v[136:139], v[160:175]
    v_exp_f32 v108, v108
    v_exp_f32 v109, v109
    v_exp_f32 v110, v110
    v_exp_f32 v111, v111
    v_cvt_pk_bf16_f32 v128, v96, v97
    v_cvt_pk_bf16_f32 v129, v98, v99
    v_mfma_f32_32x32x16_bf16 v[160:175], v[60:63], v[140:143], v[160:175]
    v_cvt_pk_bf16_f32 v130, v100, v101
    v_cvt_pk_bf16_f32 v131, v102, v103
    v_cvt_pk_bf16_f32 v132, v104, v105
    v_cvt_pk_bf16_f32 v133, v106, v107
    v_cvt_pk_bf16_f32 v134, v108, v109
    v_cvt_pk_bf16_f32 v135, v110, v111
    s_add_u32 s31, s29, 20480
    buffer_load_dwordx4 v[48:51], v5, s[4:7], s31 offen offset:0
    buffer_load_dwordx4 v[52:55], v5, s[4:7], s31 offen offset:1024
    buffer_load_dwordx4 v[56:59], v5, s[4:7], s31 offen offset:2048
    buffer_load_dwordx4 v[60:63], v5, s[4:7], s31 offen offset:3072
    s_add_u32 s55, s54, 0
    buffer_load_dwordx4 v[184:187], v5, s[4:7], s55 offen offset:2048
    s_waitcnt vmcnt(13)
    v_mfma_f32_32x32x16_bf16 v[96:111], v[80:83], v[16:19], 0
    v_exp_f32 v112, v112
    v_exp_f32 v113, v113
    v_exp_f32 v114, v114
    v_exp_f32 v115, v115
    v_exp_f32 v116, v116
    v_exp_f32 v117, v117
    v_mfma_f32_32x32x16_bf16 v[96:111], v[84:87], v[20:23], v[96:111]
    v_exp_f32 v118, v118
    v_exp_f32 v119, v119
    v_exp_f32 v120, v120
    v_exp_f32 v121, v121
    v_exp_f32 v122, v122
    v_exp_f32 v123, v123
    v_mfma_f32_32x32x16_bf16 v[144:159], v[72:75], v[128:131], v[144:159]
    v_exp_f32 v124, v124
    v_exp_f32 v125, v125
    v_exp_f32 v126, v126
    v_exp_f32 v127, v127
    v_cvt_pk_bf16_f32 v136, v112, v113
    v_cvt_pk_bf16_f32 v137, v114, v115
    v_mfma_f32_32x32x16_bf16 v[144:159], v[76:79], v[132:135], v[144:159]
    v_cvt_pk_bf16_f32 v138, v116, v117
    v_cvt_pk_bf16_f32 v139, v118, v119
    v_cvt_pk_bf16_f32 v140, v120, v121
    v_cvt_pk_bf16_f32 v141, v122, v123
    v_cvt_pk_bf16_f32 v142, v124, v125
    v_cvt_pk_bf16_f32 v143, v126, v127
    s_add_u32 s55, s54, 0
    buffer_load_dwordx4 v[188:191], v5, s[4:7], s55 offen offset:3072
    v_mfma_f32_32x32x16_bf16 v[112:127], v[80:83], v[24:27], 0
    v_exp_f32 v96, v96
    v_exp_f32 v97, v97
    v_exp_f32 v98, v98
    v_exp_f32 v99, v99
    v_exp_f32 v100, v100
    v_exp_f32 v101, v101
    v_mfma_f32_32x32x16_bf16 v[112:127], v[84:87], v[28:31], v[112:127]
    v_exp_f32 v102, v102
    v_exp_f32 v103, v103
    v_exp_f32 v104, v104
    v_exp_f32 v105, v105
    v_exp_f32 v106, v106
    v_exp_f32 v107, v107
    v_mfma_f32_32x32x16_bf16 v[160:175], v[72:75], v[136:139], v[160:175]
    v_exp_f32 v108, v108
    v_exp_f32 v109, v109
    v_exp_f32 v110, v110
    v_exp_f32 v111, v111
    v_cvt_pk_bf16_f32 v128, v96, v97
    v_cvt_pk_bf16_f32 v129, v98, v99
    v_mfma_f32_32x32x16_bf16 v[160:175], v[76:79], v[140:143], v[160:175]
    v_cvt_pk_bf16_f32 v130, v100, v101
    v_cvt_pk_bf16_f32 v131, v102, v103
    v_cvt_pk_bf16_f32 v132, v104, v105
    v_cvt_pk_bf16_f32 v133, v106, v107
    v_cvt_pk_bf16_f32 v134, v108, v109
    v_cvt_pk_bf16_f32 v135, v110, v111
    s_add_u32 s31, s29, 24576
    buffer_load_dwordx4 v[64:67], v5, s[4:7], s31 offen offset:0
    buffer_load_dwordx4 v[68:71], v5, s[4:7], s31 offen offset:1024
    buffer_load_dwordx4 v[72:75], v5, s[4:7], s31 offen offset:2048
    buffer_load_dwordx4 v[76:79], v5, s[4:7], s31 offen offset:3072
    s_add_u32 s55, s54, 4096
    buffer_load_dwordx4 v[192:195], v5, s[4:7], s55 offen offset:0
    s_waitcnt vmcnt(15)
    v_mfma_f32_32x32x16_bf16 v[96:111], v[32:35], v[16:19], 0
    v_exp_f32 v112, v112
    v_exp_f32 v113, v113
    v_exp_f32 v114, v114
    v_exp_f32 v115, v115
    v_exp_f32 v116, v116
    v_exp_f32 v117, v117
    v_mfma_f32_32x32x16_bf16 v[96:111], v[36:39], v[20:23], v[96:111]
    v_exp_f32 v118, v118
    v_exp_f32 v119, v119
    v_exp_f32 v120, v120
    v_exp_f32 v121, v121
    v_exp_f32 v122, v122
    v_exp_f32 v123, v123
    v_mfma_f32_32x32x16_bf16 v[144:159], v[88:91], v[128:131], v[144:159]
    v_exp_f32 v124, v124
    v_exp_f32 v125, v125
    v_exp_f32 v126, v126
    v_exp_f32 v127, v127
    v_cvt_pk_bf16_f32 v136, v112, v113
    v_cvt_pk_bf16_f32 v137, v114, v115
    v_mfma_f32_32x32x16_bf16 v[144:159], v[92:95], v[132:135], v[144:159]
    v_cvt_pk_bf16_f32 v138, v116, v117
    v_cvt_pk_bf16_f32 v139, v118, v119
    v_cvt_pk_bf16_f32 v140, v120, v121
    v_cvt_pk_bf16_f32 v141, v122, v123
    v_cvt_pk_bf16_f32 v142, v124, v125
    v_cvt_pk_bf16_f32 v143, v126, v127
    s_add_u32 s55, s54, 4096
    buffer_load_dwordx4 v[196:199], v5, s[4:7], s55 offen offset:1024
    s_setprio 2
    v_mfma_f32_32x32x16_bf16 v[112:127], v[32:35], v[24:27], 0
    v_exp_f32 v96, v96
    v_exp_f32 v97, v97
    v_exp_f32 v98, v98
    v_exp_f32 v99, v99
    v_exp_f32 v100, v100
    v_exp_f32 v101, v101
    v_mfma_f32_32x32x16_bf16 v[112:127], v[36:39], v[28:31], v[112:127]
    v_exp_f32 v102, v102
    v_exp_f32 v103, v103
    v_exp_f32 v104, v104
    v_exp_f32 v105, v105
    v_exp_f32 v106, v106
    v_exp_f32 v107, v107
    v_mfma_f32_32x32x16_bf16 v[160:175], v[88:91], v[136:139], v[160:175]
    v_exp_f32 v108, v108
    v_exp_f32 v109, v109
    v_exp_f32 v110, v110
    v_exp_f32 v111, v111
    v_cvt_pk_bf16_f32 v128, v96, v97
    v_cvt_pk_bf16_f32 v129, v98, v99
    v_mfma_f32_32x32x16_bf16 v[160:175], v[92:95], v[140:143], v[160:175]
    v_cvt_pk_bf16_f32 v130, v100, v101
    v_cvt_pk_bf16_f32 v131, v102, v103
    v_cvt_pk_bf16_f32 v132, v104, v105
    v_cvt_pk_bf16_f32 v133, v106, v107
    v_cvt_pk_bf16_f32 v134, v108, v109
    v_cvt_pk_bf16_f32 v135, v110, v111
    s_add_u32 s31, s29, 28672
    buffer_load_dwordx4 v[80:83], v5, s[4:7], s31 offen offset:0
    buffer_load_dwordx4 v[84:87], v5, s[4:7], s31 offen offset:1024
    buffer_load_dwordx4 v[88:91], v5, s[4:7], s31 offen offset:2048
    buffer_load_dwordx4 v[92:95], v5, s[4:7], s31 offen offset:3072
    s_add_u32 s55, s54, 4096
    buffer_load_dwordx4 v[200:203], v5, s[4:7], s55 offen offset:2048
    s_waitcnt vmcnt(15)
    v_mfma_f32_32x32x16_bf16 v[96:111], v[48:51], v[16:19], 0
    v_exp_f32 v112, v112
    v_exp_f32 v113, v113
    v_exp_f32 v114, v114
    v_exp_f32 v115, v115
    v_exp_f32 v116, v116
    v_exp_f32 v117, v117
    v_mfma_f32_32x32x16_bf16 v[96:111], v[52:55], v[20:23], v[96:111]
    v_exp_f32 v118, v118
    v_exp_f32 v119, v119
    v_exp_f32 v120, v120
    v_exp_f32 v121, v121
    v_exp_f32 v122, v122
    v_exp_f32 v123, v123
    v_mfma_f32_32x32x16_bf16 v[144:159], v[40:43], v[128:131], v[144:159]
    v_exp_f32 v124, v124
    v_exp_f32 v125, v125
    v_exp_f32 v126, v126
    v_exp_f32 v127, v127
    v_cvt_pk_bf16_f32 v136, v112, v113
    v_cvt_pk_bf16_f32 v137, v114, v115
    v_mfma_f32_32x32x16_bf16 v[144:159], v[44:47], v[132:135], v[144:159]
    v_cvt_pk_bf16_f32 v138, v116, v117
    v_cvt_pk_bf16_f32 v139, v118, v119
    v_cvt_pk_bf16_f32 v140, v120, v121
    v_cvt_pk_bf16_f32 v141, v122, v123
    v_cvt_pk_bf16_f32 v142, v124, v125
    v_cvt_pk_bf16_f32 v143, v126, v127
    s_add_u32 s55, s54, 4096
    buffer_load_dwordx4 v[204:207], v5, s[4:7], s55 offen offset:3072
    v_mfma_f32_32x32x16_bf16 v[112:127], v[48:51], v[24:27], 0
    v_exp_f32 v96, v96
    v_exp_f32 v97, v97
    v_exp_f32 v98, v98
    v_exp_f32 v99, v99
    v_exp_f32 v100, v100
    v_exp_f32 v101, v101
    v_mfma_f32_32x32x16_bf16 v[112:127], v[52:55], v[28:31], v[112:127]
    v_exp_f32 v102, v102
    v_exp_f32 v103, v103
    v_exp_f32 v104, v104
    v_exp_f32 v105, v105
    v_exp_f32 v106, v106
    v_exp_f32 v107, v107
    v_mfma_f32_32x32x16_bf16 v[160:175], v[40:43], v[136:139], v[160:175]
    v_exp_f32 v108, v108
    v_exp_f32 v109, v109
    v_exp_f32 v110, v110
    v_exp_f32 v111, v111
    v_cvt_pk_bf16_f32 v128, v96, v97
    v_cvt_pk_bf16_f32 v129, v98, v99
    v_mfma_f32_32x32x16_bf16 v[160:175], v[44:47], v[140:143], v[160:175]
    v_cvt_pk_bf16_f32 v130, v100, v101
    v_cvt_pk_bf16_f32 v131, v102, v103
    v_cvt_pk_bf16_f32 v132, v104, v105
    v_cvt_pk_bf16_f32 v133, v106, v107
    v_cvt_pk_bf16_f32 v134, v108, v109
    v_cvt_pk_bf16_f32 v135, v110, v111
    s_add_u32 s31, s29, 32768
    buffer_load_dwordx4 v[32:35], v5, s[4:7], s31 offen offset:0
    buffer_load_dwordx4 v[36:39], v5, s[4:7], s31 offen offset:1024
    buffer_load_dwordx4 v[40:43], v5, s[4:7], s31 offen offset:2048
    buffer_load_dwordx4 v[44:47], v5, s[4:7], s31 offen offset:3072
    s_add_u32 s55, s54, 8192
    buffer_load_dwordx4 v[208:211], v5, s[4:7], s55 offen offset:0
    s_waitcnt vmcnt(15)
    v_mfma_f32_32x32x16_bf16 v[96:111], v[64:67], v[16:19], 0
    v_exp_f32 v112, v112
    v_exp_f32 v113, v113
    v_exp_f32 v114, v114
    v_exp_f32 v115, v115
    v_exp_f32 v116, v116
    v_exp_f32 v117, v117
    v_mfma_f32_32x32x16_bf16 v[96:111], v[68:71], v[20:23], v[96:111]
    v_exp_f32 v118, v118
    v_exp_f32 v119, v119
    v_exp_f32 v120, v120
    v_exp_f32 v121, v121
    v_exp_f32 v122, v122
    v_exp_f32 v123, v123
    v_mfma_f32_32x32x16_bf16 v[144:159], v[56:59], v[128:131], v[144:159]
    v_exp_f32 v124, v124
    v_exp_f32 v125, v125
    v_exp_f32 v126, v126
    v_exp_f32 v127, v127
    v_cvt_pk_bf16_f32 v136, v112, v113
    v_cvt_pk_bf16_f32 v137, v114, v115
    v_mfma_f32_32x32x16_bf16 v[144:159], v[60:63], v[132:135], v[144:159]
    v_cvt_pk_bf16_f32 v138, v116, v117
    v_cvt_pk_bf16_f32 v139, v118, v119
    v_cvt_pk_bf16_f32 v140, v120, v121
    v_cvt_pk_bf16_f32 v141, v122, v123
    v_cvt_pk_bf16_f32 v142, v124, v125
    v_cvt_pk_bf16_f32 v143, v126, v127
    s_add_u32 s55, s54, 8192
    buffer_load_dwordx4 v[212:215], v5, s[4:7], s55 offen offset:1024
    v_mfma_f32_32x32x16_bf16 v[112:127], v[64:67], v[24:27], 0
    v_exp_f32 v96, v96
    v_exp_f32 v97, v97
    v_exp_f32 v98, v98
    v_exp_f32 v99, v99
    v_exp_f32 v100, v100
    v_exp_f32 v101, v101
    v_mfma_f32_32x32x16_bf16 v[112:127], v[68:71], v[28:31], v[112:127]
    v_exp_f32 v102, v102
    v_exp_f32 v103, v103
    v_exp_f32 v104, v104
    v_exp_f32 v105, v105
    v_exp_f32 v106, v106
    v_exp_f32 v107, v107
    v_mfma_f32_32x32x16_bf16 v[160:175], v[56:59], v[136:139], v[160:175]
    v_exp_f32 v108, v108
    v_exp_f32 v109, v109
    v_exp_f32 v110, v110
    v_exp_f32 v111, v111
    v_cvt_pk_bf16_f32 v128, v96, v97
    v_cvt_pk_bf16_f32 v129, v98, v99
    v_mfma_f32_32x32x16_bf16 v[160:175], v[60:63], v[140:143], v[160:175]
    v_cvt_pk_bf16_f32 v130, v100, v101
    v_cvt_pk_bf16_f32 v131, v102, v103
    v_cvt_pk_bf16_f32 v132, v104, v105
    v_cvt_pk_bf16_f32 v133, v106, v107
    v_cvt_pk_bf16_f32 v134, v108, v109
    v_cvt_pk_bf16_f32 v135, v110, v111
    s_add_u32 s31, s29, 36864
    buffer_load_dwordx4 v[48:51], v5, s[4:7], s31 offen offset:0
    buffer_load_dwordx4 v[52:55], v5, s[4:7], s31 offen offset:1024
    buffer_load_dwordx4 v[56:59], v5, s[4:7], s31 offen offset:2048
    buffer_load_dwordx4 v[60:63], v5, s[4:7], s31 offen offset:3072
    s_add_u32 s55, s54, 8192
    buffer_load_dwordx4 v[216:219], v5, s[4:7], s55 offen offset:2048
    s_waitcnt vmcnt(15)
    v_mfma_f32_32x32x16_bf16 v[96:111], v[80:83], v[16:19], 0
    v_exp_f32 v112, v112
    v_exp_f32 v113, v113
    v_exp_f32 v114, v114
    v_exp_f32 v115, v115
    v_exp_f32 v116, v116
    v_exp_f32 v117, v117
    v_mfma_f32_32x32x16_bf16 v[96:111], v[84:87], v[20:23], v[96:111]
    v_exp_f32 v118, v118
    v_exp_f32 v119, v119
    v_exp_f32 v120, v120
    v_exp_f32 v121, v121
    v_exp_f32 v122, v122
    v_exp_f32 v123, v123
    v_mfma_f32_32x32x16_bf16 v[144:159], v[72:75], v[128:131], v[144:159]
    v_exp_f32 v124, v124
    v_exp_f32 v125, v125
    v_exp_f32 v126, v126
    v_exp_f32 v127, v127
    v_cvt_pk_bf16_f32 v136, v112, v113
    v_cvt_pk_bf16_f32 v137, v114, v115
    v_mfma_f32_32x32x16_bf16 v[144:159], v[76:79], v[132:135], v[144:159]
    v_cvt_pk_bf16_f32 v138, v116, v117
    v_cvt_pk_bf16_f32 v139, v118, v119
    v_cvt_pk_bf16_f32 v140, v120, v121
    v_cvt_pk_bf16_f32 v141, v122, v123
    v_cvt_pk_bf16_f32 v142, v124, v125
    v_cvt_pk_bf16_f32 v143, v126, v127
    s_add_u32 s55, s54, 8192
    buffer_load_dwordx4 v[220:223], v5, s[4:7], s55 offen offset:3072
    v_mfma_f32_32x32x16_bf16 v[112:127], v[80:83], v[24:27], 0
    v_exp_f32 v96, v96
    v_exp_f32 v97, v97
    v_exp_f32 v98, v98
    v_exp_f32 v99, v99
    v_exp_f32 v100, v100
    v_exp_f32 v101, v101
    v_mfma_f32_32x32x16_bf16 v[112:127], v[84:87], v[28:31], v[112:127]
    v_exp_f32 v102, v102
    v_exp_f32 v103, v103
    v_exp_f32 v104, v104
    v_exp_f32 v105, v105
    v_exp_f32 v106, v106
    v_exp_f32 v107, v107
    v_mfma_f32_32x32x16_bf16 v[160:175], v[72:75], v[136:139], v[160:175]
    v_exp_f32 v108, v108
    v_exp_f32 v109, v109
    v_exp_f32 v110, v110
    v_exp_f32 v111, v111
    v_cvt_pk_bf16_f32 v128, v96, v97
    v_cvt_pk_bf16_f32 v129, v98, v99
    v_mfma_f32_32x32x16_bf16 v[160:175], v[76:79], v[140:143], v[160:175]
    v_cvt_pk_bf16_f32 v130, v100, v101
    v_cvt_pk_bf16_f32 v131, v102, v103
    v_cvt_pk_bf16_f32 v132, v104, v105
    v_cvt_pk_bf16_f32 v133, v106, v107
    v_cvt_pk_bf16_f32 v134, v108, v109
    v_cvt_pk_bf16_f32 v135, v110, v111
    s_add_u32 s31, s29, 40960
    buffer_load_dwordx4 v[64:67], v5, s[4:7], s31 offen offset:0
    buffer_load_dwordx4 v[68:71], v5, s[4:7], s31 offen offset:1024
    buffer_load_dwordx4 v[72:75], v5, s[4:7], s31 offen offset:2048
    buffer_load_dwordx4 v[76:79], v5, s[4:7], s31 offen offset:3072
    s_add_u32 s55, s54, 12288
    buffer_load_dwordx4 v[224:227], v5, s[4:7], s55 offen offset:0
    s_waitcnt vmcnt(15)
    v_mfma_f32_32x32x16_bf16 v[96:111], v[32:35], v[16:19], 0
    v_exp_f32 v112, v112
    v_exp_f32 v113, v113
    v_exp_f32 v114, v114
    v_exp_f32 v115, v115
    v_exp_f32 v116, v116
    v_exp_f32 v117, v117
    v_mfma_f32_32x32x16_bf16 v[96:111], v[36:39], v[20:23], v[96:111]
    v_exp_f32 v118, v118
    v_exp_f32 v119, v119
    v_exp_f32 v120, v120
    v_exp_f32 v121, v121
    v_exp_f32 v122, v122
    v_exp_f32 v123, v123
    v_mfma_f32_32x32x16_bf16 v[144:159], v[88:91], v[128:131], v[144:159]
    v_exp_f32 v124, v124
    v_exp_f32 v125, v125
    v_exp_f32 v126, v126
    v_exp_f32 v127, v127
    v_cvt_pk_bf16_f32 v136, v112, v113
    v_cvt_pk_bf16_f32 v137, v114, v115
    v_mfma_f32_32x32x16_bf16 v[144:159], v[92:95], v[132:135], v[144:159]
    v_cvt_pk_bf16_f32 v138, v116, v117
    v_cvt_pk_bf16_f32 v139, v118, v119
    v_cvt_pk_bf16_f32 v140, v120, v121
    v_cvt_pk_bf16_f32 v141, v122, v123
    v_cvt_pk_bf16_f32 v142, v124, v125
    v_cvt_pk_bf16_f32 v143, v126, v127
    s_add_u32 s55, s54, 12288
    buffer_load_dwordx4 v[228:231], v5, s[4:7], s55 offen offset:1024
    s_setprio 1
    v_mfma_f32_32x32x16_bf16 v[112:127], v[32:35], v[24:27], 0
    v_exp_f32 v96, v96
    v_exp_f32 v97, v97
    v_exp_f32 v98, v98
    v_exp_f32 v99, v99
    v_exp_f32 v100, v100
    v_exp_f32 v101, v101
    v_mfma_f32_32x32x16_bf16 v[112:127], v[36:39], v[28:31], v[112:127]
    v_exp_f32 v102, v102
    v_exp_f32 v103, v103
    v_exp_f32 v104, v104
    v_exp_f32 v105, v105
    v_exp_f32 v106, v106
    v_exp_f32 v107, v107
    v_mfma_f32_32x32x16_bf16 v[160:175], v[88:91], v[136:139], v[160:175]
    v_exp_f32 v108, v108
    v_exp_f32 v109, v109
    v_exp_f32 v110, v110
    v_exp_f32 v111, v111
    v_cvt_pk_bf16_f32 v128, v96, v97
    v_cvt_pk_bf16_f32 v129, v98, v99
    v_mfma_f32_32x32x16_bf16 v[160:175], v[92:95], v[140:143], v[160:175]
    v_cvt_pk_bf16_f32 v130, v100, v101
    v_cvt_pk_bf16_f32 v131, v102, v103
    v_cvt_pk_bf16_f32 v132, v104, v105
    v_cvt_pk_bf16_f32 v133, v106, v107
    v_cvt_pk_bf16_f32 v134, v108, v109
    v_cvt_pk_bf16_f32 v135, v110, v111
    s_add_u32 s31, s29, 45056
    buffer_load_dwordx4 v[80:83], v5, s[4:7], s31 offen offset:0
    buffer_load_dwordx4 v[84:87], v5, s[4:7], s31 offen offset:1024
    buffer_load_dwordx4 v[88:91], v5, s[4:7], s31 offen offset:2048
    buffer_load_dwordx4 v[92:95], v5, s[4:7], s31 offen offset:3072
    s_add_u32 s55, s54, 12288
    buffer_load_dwordx4 v[232:235], v5, s[4:7], s55 offen offset:2048
    s_waitcnt vmcnt(15)
    v_mfma_f32_32x32x16_bf16 v[96:111], v[48:51], v[16:19], 0
    v_exp_f32 v112, v112
    v_exp_f32 v113, v113
    v_exp_f32 v114, v114
    v_exp_f32 v115, v115
    v_exp_f32 v116, v116
    v_exp_f32 v117, v117
    v_mfma_f32_32x32x16_bf16 v[96:111], v[52:55], v[20:23], v[96:111]
    v_exp_f32 v118, v118
    v_exp_f32 v119, v119
    v_exp_f32 v120, v120
    v_exp_f32 v121, v121
    v_exp_f32 v122, v122
    v_exp_f32 v123, v123
    v_mfma_f32_32x32x16_bf16 v[144:159], v[40:43], v[128:131], v[144:159]
    v_exp_f32 v124, v124
    v_exp_f32 v125, v125
    v_exp_f32 v126, v126
    v_exp_f32 v127, v127
    v_cvt_pk_bf16_f32 v136, v112, v113
    v_cvt_pk_bf16_f32 v137, v114, v115
    v_mfma_f32_32x32x16_bf16 v[144:159], v[44:47], v[132:135], v[144:159]
    v_cvt_pk_bf16_f32 v138, v116, v117
    v_cvt_pk_bf16_f32 v139, v118, v119
    v_cvt_pk_bf16_f32 v140, v120, v121
    v_cvt_pk_bf16_f32 v141, v122, v123
    v_cvt_pk_bf16_f32 v142, v124, v125
    v_cvt_pk_bf16_f32 v143, v126, v127
    s_add_u32 s55, s54, 12288
    buffer_load_dwordx4 v[236:239], v5, s[4:7], s55 offen offset:3072
    v_mfma_f32_32x32x16_bf16 v[112:127], v[48:51], v[24:27], 0
    v_exp_f32 v96, v96
    v_exp_f32 v97, v97
    v_exp_f32 v98, v98
    v_exp_f32 v99, v99
    v_exp_f32 v100, v100
    v_exp_f32 v101, v101
    v_mfma_f32_32x32x16_bf16 v[112:127], v[52:55], v[28:31], v[112:127]
    v_exp_f32 v102, v102
    v_exp_f32 v103, v103
    v_exp_f32 v104, v104
    v_exp_f32 v105, v105
    v_exp_f32 v106, v106
    v_exp_f32 v107, v107
    v_mfma_f32_32x32x16_bf16 v[160:175], v[40:43], v[136:139], v[160:175]
    v_exp_f32 v108, v108
    v_exp_f32 v109, v109
    v_exp_f32 v110, v110
    v_exp_f32 v111, v111
    v_cvt_pk_bf16_f32 v128, v96, v97
    v_cvt_pk_bf16_f32 v129, v98, v99
    v_mfma_f32_32x32x16_bf16 v[160:175], v[44:47], v[140:143], v[160:175]
    v_cvt_pk_bf16_f32 v130, v100, v101
    v_cvt_pk_bf16_f32 v131, v102, v103
    v_cvt_pk_bf16_f32 v132, v104, v105
    v_cvt_pk_bf16_f32 v133, v106, v107
    v_cvt_pk_bf16_f32 v134, v108, v109
    v_cvt_pk_bf16_f32 v135, v110, v111
    s_add_u32 s31, s29, 49152
    buffer_load_dwordx4 v[32:35], v5, s[4:7], s31 offen offset:0
    buffer_load_dwordx4 v[36:39], v5, s[4:7], s31 offen offset:1024
    buffer_load_dwordx4 v[40:43], v5, s[4:7], s31 offen offset:2048
    buffer_load_dwordx4 v[44:47], v5, s[4:7], s31 offen offset:3072
    s_add_u32 s55, s54, 16384
    buffer_load_dwordx4 v[240:243], v5, s[4:7], s55 offen offset:0
    s_waitcnt vmcnt(15)
    v_mfma_f32_32x32x16_bf16 v[96:111], v[64:67], v[16:19], 0
    v_exp_f32 v112, v112
    v_exp_f32 v113, v113
    v_exp_f32 v114, v114
    v_exp_f32 v115, v115
    v_exp_f32 v116, v116
    v_exp_f32 v117, v117
    v_mfma_f32_32x32x16_bf16 v[96:111], v[68:71], v[20:23], v[96:111]
    v_exp_f32 v118, v118
    v_exp_f32 v119, v119
    v_exp_f32 v120, v120
    v_exp_f32 v121, v121
    v_exp_f32 v122, v122
    v_exp_f32 v123, v123
    v_mfma_f32_32x32x16_bf16 v[144:159], v[56:59], v[128:131], v[144:159]
    v_exp_f32 v124, v124
    v_exp_f32 v125, v125
    v_exp_f32 v126, v126
    v_exp_f32 v127, v127
    v_cvt_pk_bf16_f32 v136, v112, v113
    v_cvt_pk_bf16_f32 v137, v114, v115
    v_mfma_f32_32x32x16_bf16 v[144:159], v[60:63], v[132:135], v[144:159]
    v_cvt_pk_bf16_f32 v138, v116, v117
    v_cvt_pk_bf16_f32 v139, v118, v119
    v_cvt_pk_bf16_f32 v140, v120, v121
    v_cvt_pk_bf16_f32 v141, v122, v123
    v_cvt_pk_bf16_f32 v142, v124, v125
    v_cvt_pk_bf16_f32 v143, v126, v127
    s_add_u32 s55, s54, 16384
    buffer_load_dwordx4 v[244:247], v5, s[4:7], s55 offen offset:1024
    v_mfma_f32_32x32x16_bf16 v[112:127], v[64:67], v[24:27], 0
    v_exp_f32 v96, v96
    v_exp_f32 v97, v97
    v_exp_f32 v98, v98
    v_exp_f32 v99, v99
    v_exp_f32 v100, v100
    v_exp_f32 v101, v101
    v_mfma_f32_32x32x16_bf16 v[112:127], v[68:71], v[28:31], v[112:127]
    v_exp_f32 v102, v102
    v_exp_f32 v103, v103
    v_exp_f32 v104, v104
    v_exp_f32 v105, v105
    v_exp_f32 v106, v106
    v_exp_f32 v107, v107
    v_mfma_f32_32x32x16_bf16 v[160:175], v[56:59], v[136:139], v[160:175]
    v_exp_f32 v108, v108
    v_exp_f32 v109, v109
    v_exp_f32 v110, v110
    v_exp_f32 v111, v111
    v_cvt_pk_bf16_f32 v128, v96, v97
    v_cvt_pk_bf16_f32 v129, v98, v99
    v_mfma_f32_32x32x16_bf16 v[160:175], v[60:63], v[140:143], v[160:175]
    v_cvt_pk_bf16_f32 v130, v100, v101
    v_cvt_pk_bf16_f32 v131, v102, v103
    v_cvt_pk_bf16_f32 v132, v104, v105
    v_cvt_pk_bf16_f32 v133, v106, v107
    v_cvt_pk_bf16_f32 v134, v108, v109
    v_cvt_pk_bf16_f32 v135, v110, v111
    s_add_u32 s31, s29, 53248
    buffer_load_dwordx4 v[48:51], v5, s[4:7], s31 offen offset:0
    buffer_load_dwordx4 v[52:55], v5, s[4:7], s31 offen offset:1024
    buffer_load_dwordx4 v[56:59], v5, s[4:7], s31 offen offset:2048
    buffer_load_dwordx4 v[60:63], v5, s[4:7], s31 offen offset:3072
    s_add_u32 s55, s54, 16384
    buffer_load_dwordx4 v[248:251], v5, s[4:7], s55 offen offset:2048
    s_waitcnt vmcnt(15)
    v_mfma_f32_32x32x16_bf16 v[96:111], v[80:83], v[16:19], 0
    v_exp_f32 v112, v112
    v_exp_f32 v113, v113
    v_exp_f32 v114, v114
    v_exp_f32 v115, v115
    v_exp_f32 v116, v116
    v_exp_f32 v117, v117
    v_mfma_f32_32x32x16_bf16 v[96:111], v[84:87], v[20:23], v[96:111]
    v_exp_f32 v118, v118
    v_exp_f32 v119, v119
    v_exp_f32 v120, v120
    v_exp_f32 v121, v121
    v_exp_f32 v122, v122
    v_exp_f32 v123, v123
    v_mfma_f32_32x32x16_bf16 v[144:159], v[72:75], v[128:131], v[144:159]
    v_exp_f32 v124, v124
    v_exp_f32 v125, v125
    v_exp_f32 v126, v126
    v_exp_f32 v127, v127
    v_cvt_pk_bf16_f32 v136, v112, v113
    v_cvt_pk_bf16_f32 v137, v114, v115
    v_mfma_f32_32x32x16_bf16 v[144:159], v[76:79], v[132:135], v[144:159]
    v_cvt_pk_bf16_f32 v138, v116, v117
    v_cvt_pk_bf16_f32 v139, v118, v119
    v_cvt_pk_bf16_f32 v140, v120, v121
    v_cvt_pk_bf16_f32 v141, v122, v123
    v_cvt_pk_bf16_f32 v142, v124, v125
    v_cvt_pk_bf16_f32 v143, v126, v127
    s_add_u32 s55, s54, 16384
    buffer_load_dwordx4 v[252:255], v5, s[4:7], s55 offen offset:3072
    v_mfma_f32_32x32x16_bf16 v[112:127], v[80:83], v[24:27], 0
    v_exp_f32 v96, v96
    v_exp_f32 v97, v97
    v_exp_f32 v98, v98
    v_exp_f32 v99, v99
    v_exp_f32 v100, v100
    v_exp_f32 v101, v101
    v_mfma_f32_32x32x16_bf16 v[112:127], v[84:87], v[28:31], v[112:127]
    v_exp_f32 v102, v102
    v_exp_f32 v103, v103
    v_exp_f32 v104, v104
    v_exp_f32 v105, v105
    v_exp_f32 v106, v106
    v_exp_f32 v107, v107
    v_mfma_f32_32x32x16_bf16 v[160:175], v[72:75], v[136:139], v[160:175]
    v_exp_f32 v108, v108
    v_exp_f32 v109, v109
    v_exp_f32 v110, v110
    v_exp_f32 v111, v111
    v_cvt_pk_bf16_f32 v128, v96, v97
    v_cvt_pk_bf16_f32 v129, v98, v99
    v_mfma_f32_32x32x16_bf16 v[160:175], v[76:79], v[140:143], v[160:175]
    v_cvt_pk_bf16_f32 v130, v100, v101
    v_cvt_pk_bf16_f32 v131, v102, v103
    v_cvt_pk_bf16_f32 v132, v104, v105
    v_cvt_pk_bf16_f32 v133, v106, v107
    v_cvt_pk_bf16_f32 v134, v108, v109
    v_cvt_pk_bf16_f32 v135, v110, v111
    s_add_u32 s31, s29, 57344
    buffer_load_dwordx4 v[64:67], v5, s[4:7], s31 offen offset:0
    buffer_load_dwordx4 v[68:71], v5, s[4:7], s31 offen offset:1024
    buffer_load_dwordx4 v[72:75], v5, s[4:7], s31 offen offset:2048
    buffer_load_dwordx4 v[76:79], v5, s[4:7], s31 offen offset:3072
    s_lshl_b32 s52, s51, 16
    s_lshl_b32 s53, s3, 10
    s_add_u32 s52, s52, s53
    s_add_u32 s52, s52, 0xa80000
    s_add_u32 s53, s53, 69632
    s_add_u32 m0, s53, 0
    s_add_u32 s55, s52, 0
    buffer_load_dwordx4 v5, s[4:7], s55 offen lds
    s_waitcnt vmcnt(15)
    v_mfma_f32_32x32x16_bf16 v[96:111], v[32:35], v[16:19], 0
    v_exp_f32 v112, v112
    v_exp_f32 v113, v113
    v_exp_f32 v114, v114
    v_exp_f32 v115, v115
    v_exp_f32 v116, v116
    v_exp_f32 v117, v117
    v_mfma_f32_32x32x16_bf16 v[96:111], v[36:39], v[20:23], v[96:111]
    v_exp_f32 v118, v118
    v_exp_f32 v119, v119
    v_exp_f32 v120, v120
    v_exp_f32 v121, v121
    v_exp_f32 v122, v122
    v_exp_f32 v123, v123
    v_mfma_f32_32x32x16_bf16 v[144:159], v[88:91], v[128:131], v[144:159]
    v_exp_f32 v124, v124
    v_exp_f32 v125, v125
    v_exp_f32 v126, v126
    v_exp_f32 v127, v127
    v_cvt_pk_bf16_f32 v136, v112, v113
    v_cvt_pk_bf16_f32 v137, v114, v115
    v_mfma_f32_32x32x16_bf16 v[144:159], v[92:95], v[132:135], v[144:159]
    v_cvt_pk_bf16_f32 v138, v116, v117
    v_cvt_pk_bf16_f32 v139, v118, v119
    v_cvt_pk_bf16_f32 v140, v120, v121
    v_cvt_pk_bf16_f32 v141, v122, v123
    v_cvt_pk_bf16_f32 v142, v124, v125
    v_cvt_pk_bf16_f32 v143, v126, v127
    s_add_u32 m0, s53, 8192
    s_add_u32 s55, s52, 8192
    buffer_load_dwordx4 v5, s[4:7], s55 offen lds
    s_setprio 0
    v_mfma_f32_32x32x16_bf16 v[112:127], v[32:35], v[24:27], 0
    v_exp_f32 v96, v96
    v_exp_f32 v97, v97
    v_exp_f32 v98, v98
    v_exp_f32 v99, v99
    v_exp_f32 v100, v100
    v_exp_f32 v101, v101
    v_mfma_f32_32x32x16_bf16 v[112:127], v[36:39], v[28:31], v[112:127]
    v_exp_f32 v102, v102
    v_exp_f32 v103, v103
    v_exp_f32 v104, v104
    v_exp_f32 v105, v105
    v_exp_f32 v106, v106
    v_exp_f32 v107, v107
    v_mfma_f32_32x32x16_bf16 v[160:175], v[88:91], v[136:139], v[160:175]
    v_exp_f32 v108, v108
    v_exp_f32 v109, v109
    v_exp_f32 v110, v110
    v_exp_f32 v111, v111
    v_cvt_pk_bf16_f32 v128, v96, v97
    v_cvt_pk_bf16_f32 v129, v98, v99
    v_mfma_f32_32x32x16_bf16 v[160:175], v[92:95], v[140:143], v[160:175]
    v_cvt_pk_bf16_f32 v130, v100, v101
    v_cvt_pk_bf16_f32 v131, v102, v103
    v_cvt_pk_bf16_f32 v132, v104, v105
    v_cvt_pk_bf16_f32 v133, v106, v107
    v_cvt_pk_bf16_f32 v134, v108, v109
    v_cvt_pk_bf16_f32 v135, v110, v111
    s_add_u32 s31, s29, 61440
    buffer_load_dwordx4 v[80:83], v5, s[4:7], s31 offen offset:0
    buffer_load_dwordx4 v[84:87], v5, s[4:7], s31 offen offset:1024
    buffer_load_dwordx4 v[88:91], v5, s[4:7], s31 offen offset:2048
    buffer_load_dwordx4 v[92:95], v5, s[4:7], s31 offen offset:3072
    s_add_u32 m0, s53, 16384
    s_add_u32 s55, s52, 16384
    buffer_load_dwordx4 v5, s[4:7], s55 offen lds
    s_waitcnt vmcnt(15)
    v_mfma_f32_32x32x16_bf16 v[96:111], v[48:51], v[16:19], 0
    v_exp_f32 v112, v112
    v_exp_f32 v113, v113
    v_exp_f32 v114, v114
    v_exp_f32 v115, v115
    v_exp_f32 v116, v116
    v_exp_f32 v117, v117
    v_mfma_f32_32x32x16_bf16 v[96:111], v[52:55], v[20:23], v[96:111]
    v_exp_f32 v118, v118
    v_exp_f32 v119, v119
    v_exp_f32 v120, v120
    v_exp_f32 v121, v121
    v_exp_f32 v122, v122
    v_exp_f32 v123, v123
    v_mfma_f32_32x32x16_bf16 v[144:159], v[40:43], v[128:131], v[144:159]
    v_exp_f32 v124, v124
    v_exp_f32 v125, v125
    v_exp_f32 v126, v126
    v_exp_f32 v127, v127
    v_cvt_pk_bf16_f32 v136, v112, v113
    v_cvt_pk_bf16_f32 v137, v114, v115
    v_mfma_f32_32x32x16_bf16 v[144:159], v[44:47], v[132:135], v[144:159]
    v_cvt_pk_bf16_f32 v138, v116, v117
    v_cvt_pk_bf16_f32 v139, v118, v119
    v_cvt_pk_bf16_f32 v140, v120, v121
    v_cvt_pk_bf16_f32 v141, v122, v123
    v_cvt_pk_bf16_f32 v142, v124, v125
    v_cvt_pk_bf16_f32 v143, v126, v127
    s_add_u32 m0, s53, 24576
    s_add_u32 s55, s52, 24576
    buffer_load_dwordx4 v5, s[4:7], s55 offen lds
    v_mfma_f32_32x32x16_bf16 v[112:127], v[48:51], v[24:27], 0
    v_exp_f32 v96, v96
    v_exp_f32 v97, v97
    v_exp_f32 v98, v98
    v_exp_f32 v99, v99
    v_exp_f32 v100, v100
    v_exp_f32 v101, v101
    v_mfma_f32_32x32x16_bf16 v[112:127], v[52:55], v[28:31], v[112:127]
    v_exp_f32 v102, v102
    v_exp_f32 v103, v103
    v_exp_f32 v104, v104
    v_exp_f32 v105, v105
    v_exp_f32 v106, v106
    v_exp_f32 v107, v107
    v_mfma_f32_32x32x16_bf16 v[160:175], v[40:43], v[136:139], v[160:175]
    v_exp_f32 v108, v108
    v_exp_f32 v109, v109
    v_exp_f32 v110, v110
    v_exp_f32 v111, v111
    v_cvt_pk_bf16_f32 v128, v96, v97
    v_cvt_pk_bf16_f32 v129, v98, v99
    v_mfma_f32_32x32x16_bf16 v[160:175], v[44:47], v[140:143], v[160:175]
    v_cvt_pk_bf16_f32 v130, v100, v101
    v_cvt_pk_bf16_f32 v131, v102, v103
    v_cvt_pk_bf16_f32 v132, v104, v105
    v_cvt_pk_bf16_f32 v133, v106, v107
    v_cvt_pk_bf16_f32 v134, v108, v109
    v_cvt_pk_bf16_f32 v135, v110, v111
    s_add_u32 m0, s53, 32768
    s_add_u32 s55, s52, 32768
    buffer_load_dwordx4 v5, s[4:7], s55 offen lds
    s_waitcnt vmcnt(11)
    v_mfma_f32_32x32x16_bf16 v[96:111], v[64:67], v[16:19], 0
    v_exp_f32 v112, v112
    v_exp_f32 v113, v113
    v_exp_f32 v114, v114
    v_exp_f32 v115, v115
    v_exp_f32 v116, v116
    v_exp_f32 v117, v117
    v_mfma_f32_32x32x16_bf16 v[96:111], v[68:71], v[20:23], v[96:111]
    v_exp_f32 v118, v118
    v_exp_f32 v119, v119
    v_exp_f32 v120, v120
    v_exp_f32 v121, v121
    v_exp_f32 v122, v122
    v_exp_f32 v123, v123
    v_mfma_f32_32x32x16_bf16 v[144:159], v[56:59], v[128:131], v[144:159]
    v_exp_f32 v124, v124
    v_exp_f32 v125, v125
    v_exp_f32 v126, v126
    v_exp_f32 v127, v127
    v_cvt_pk_bf16_f32 v136, v112, v113
    v_cvt_pk_bf16_f32 v137, v114, v115
    v_mfma_f32_32x32x16_bf16 v[144:159], v[60:63], v[132:135], v[144:159]
    v_cvt_pk_bf16_f32 v138, v116, v117
    v_cvt_pk_bf16_f32 v139, v118, v119
    v_cvt_pk_bf16_f32 v140, v120, v121
    v_cvt_pk_bf16_f32 v141, v122, v123
    v_cvt_pk_bf16_f32 v142, v124, v125
    v_cvt_pk_bf16_f32 v143, v126, v127
    s_add_u32 m0, s53, 40960
    s_add_u32 s55, s52, 40960
    buffer_load_dwordx4 v5, s[4:7], s55 offen lds
    v_mfma_f32_32x32x16_bf16 v[112:127], v[64:67], v[24:27], 0
    v_exp_f32 v96, v96
    v_exp_f32 v97, v97
    v_exp_f32 v98, v98
    v_exp_f32 v99, v99
    v_exp_f32 v100, v100
    v_exp_f32 v101, v101
    v_mfma_f32_32x32x16_bf16 v[112:127], v[68:71], v[28:31], v[112:127]
    v_exp_f32 v102, v102
    v_exp_f32 v103, v103
    v_exp_f32 v104, v104
    v_exp_f32 v105, v105
    v_exp_f32 v106, v106
    v_exp_f32 v107, v107
    v_mfma_f32_32x32x16_bf16 v[160:175], v[56:59], v[136:139], v[160:175]
    v_exp_f32 v108, v108
    v_exp_f32 v109, v109
    v_exp_f32 v110, v110
    v_exp_f32 v111, v111
    v_cvt_pk_bf16_f32 v128, v96, v97
    v_cvt_pk_bf16_f32 v129, v98, v99
    v_mfma_f32_32x32x16_bf16 v[160:175], v[60:63], v[140:143], v[160:175]
    v_cvt_pk_bf16_f32 v130, v100, v101
    v_cvt_pk_bf16_f32 v131, v102, v103
    v_cvt_pk_bf16_f32 v132, v104, v105
    v_cvt_pk_bf16_f32 v133, v106, v107
    v_cvt_pk_bf16_f32 v134, v108, v109
    v_cvt_pk_bf16_f32 v135, v110, v111
    s_add_u32 m0, s53, 49152
    s_add_u32 s55, s52, 49152
    buffer_load_dwordx4 v5, s[4:7], s55 offen lds
    s_waitcnt vmcnt(7)
    v_mfma_f32_32x32x16_bf16 v[96:111], v[80:83], v[16:19], 0
    v_exp_f32 v112, v112
    v_exp_f32 v113, v113
    v_exp_f32 v114, v114
    v_exp_f32 v115, v115
    v_exp_f32 v116, v116
    v_exp_f32 v117, v117
    v_mfma_f32_32x32x16_bf16 v[96:111], v[84:87], v[20:23], v[96:111]
    v_exp_f32 v118, v118
    v_exp_f32 v119, v119
    v_exp_f32 v120, v120
    v_exp_f32 v121, v121
    v_exp_f32 v122, v122
    v_exp_f32 v123, v123
    v_mfma_f32_32x32x16_bf16 v[144:159], v[72:75], v[128:131], v[144:159]
    v_exp_f32 v124, v124
    v_exp_f32 v125, v125
    v_exp_f32 v126, v126
    v_exp_f32 v127, v127
    v_cvt_pk_bf16_f32 v136, v112, v113
    v_cvt_pk_bf16_f32 v137, v114, v115
    v_mfma_f32_32x32x16_bf16 v[144:159], v[76:79], v[132:135], v[144:159]
    v_cvt_pk_bf16_f32 v138, v116, v117
    v_cvt_pk_bf16_f32 v139, v118, v119
    v_cvt_pk_bf16_f32 v140, v120, v121
    v_cvt_pk_bf16_f32 v141, v122, v123
    v_cvt_pk_bf16_f32 v142, v124, v125
    v_cvt_pk_bf16_f32 v143, v126, v127
    s_add_u32 m0, s53, 57344
    s_add_u32 s55, s52, 57344
    buffer_load_dwordx4 v5, s[4:7], s55 offen lds
    v_mfma_f32_32x32x16_bf16 v[112:127], v[80:83], v[24:27], 0
    v_exp_f32 v96, v96
    v_exp_f32 v97, v97
    v_exp_f32 v98, v98
    v_exp_f32 v99, v99
    v_exp_f32 v100, v100
    v_exp_f32 v101, v101
    v_mfma_f32_32x32x16_bf16 v[112:127], v[84:87], v[28:31], v[112:127]
    v_exp_f32 v102, v102
    v_exp_f32 v103, v103
    v_exp_f32 v104, v104
    v_exp_f32 v105, v105
    v_exp_f32 v106, v106
    v_exp_f32 v107, v107
    v_mfma_f32_32x32x16_bf16 v[160:175], v[72:75], v[136:139], v[160:175]
    v_exp_f32 v108, v108
    v_exp_f32 v109, v109
    v_exp_f32 v110, v110
    v_exp_f32 v111, v111
    v_cvt_pk_bf16_f32 v128, v96, v97
    v_cvt_pk_bf16_f32 v129, v98, v99
    v_mfma_f32_32x32x16_bf16 v[160:175], v[76:79], v[140:143], v[160:175]
    v_cvt_pk_bf16_f32 v130, v100, v101
    v_cvt_pk_bf16_f32 v131, v102, v103
    v_cvt_pk_bf16_f32 v132, v104, v105
    v_cvt_pk_bf16_f32 v133, v106, v107
    v_cvt_pk_bf16_f32 v134, v108, v109
    v_cvt_pk_bf16_f32 v135, v110, v111
    s_waitcnt vmcnt(6)
    v_exp_f32 v112, v112
    v_exp_f32 v113, v113
    v_exp_f32 v114, v114
    v_exp_f32 v115, v115
    v_exp_f32 v116, v116
    v_exp_f32 v117, v117
    v_exp_f32 v118, v118
    v_exp_f32 v119, v119
    v_exp_f32 v120, v120
    v_exp_f32 v121, v121
    v_exp_f32 v122, v122
    v_exp_f32 v123, v123
    v_mfma_f32_32x32x16_bf16 v[144:159], v[88:91], v[128:131], v[144:159]
    v_exp_f32 v124, v124
    v_exp_f32 v125, v125
    v_exp_f32 v126, v126
    v_exp_f32 v127, v127
    v_cvt_pk_bf16_f32 v136, v112, v113
    v_cvt_pk_bf16_f32 v137, v114, v115
    v_mfma_f32_32x32x16_bf16 v[144:159], v[92:95], v[132:135], v[144:159]
    v_cvt_pk_bf16_f32 v138, v116, v117
    v_cvt_pk_bf16_f32 v139, v118, v119
    v_cvt_pk_bf16_f32 v140, v120, v121
    v_cvt_pk_bf16_f32 v141, v122, v123
    v_cvt_pk_bf16_f32 v142, v124, v125
    v_cvt_pk_bf16_f32 v143, v126, v127
    s_nop 1
    v_mfma_f32_32x32x16_bf16 v[160:175], v[88:91], v[136:139], v[160:175]
    v_mfma_f32_32x32x16_bf16 v[160:175], v[92:95], v[140:143], v[160:175]
    s_add_u32 s55, s54, 20480
    buffer_load_dwordx4 v[96:99], v5, s[4:7], s55 offen offset:0
    s_add_u32 s55, s54, 20480
    buffer_load_dwordx4 v[100:103], v5, s[4:7], s55 offen offset:1024
    s_add_u32 s55, s54, 20480
    buffer_load_dwordx4 v[104:107], v5, s[4:7], s55 offen offset:2048
    s_add_u32 s55, s54, 20480
    buffer_load_dwordx4 v[108:111], v5, s[4:7], s55 offen offset:3072
    s_add_u32 s55, s54, 24576
    buffer_load_dwordx4 v[112:115], v5, s[4:7], s55 offen offset:0
    s_add_u32 s55, s54, 24576
    buffer_load_dwordx4 v[116:119], v5, s[4:7], s55 offen offset:1024
    s_add_u32 s55, s54, 24576
    buffer_load_dwordx4 v[120:123], v5, s[4:7], s55 offen offset:2048
    s_add_u32 s55, s54, 24576
    buffer_load_dwordx4 v[124:127], v5, s[4:7], s55 offen offset:3072
    s_nop 7
    s_lshl_b32 s33, s3, 13
    v_add_u32 v8, s33, v5
    ds_write_b128 v8, v[144:147] offset:0
    ds_write_b128 v8, v[148:151] offset:1024
    ds_write_b128 v8, v[152:155] offset:2048
    ds_write_b128 v8, v[156:159] offset:3072
    ds_write_b128 v8, v[160:163] offset:4096
    ds_write_b128 v8, v[164:167] offset:5120
    ds_write_b128 v8, v[168:171] offset:6144
    ds_write_b128 v8, v[172:175] offset:7168
    s_waitcnt lgkmcnt(0)
    s_barrier
    s_lshr_b32 s34, s24, 1
    s_and_b32 s35, s24, 1
    s_lshl_b32 s36, s23, 13
    s_lshl_b32 s37, s34, 12
    s_add_u32 s36, s36, s37
    s_lshl_b32 s37, s35, 11
    s_add_u32 s37, s37, s36
    v_add_u32 v8, s37, v5
    v_lshlrev_b32 v9, 4, v4
    v_add_u32 v9, 3584, v9
    v_add_u32 v9, s36, v9
    ds_read_b128 v[32:35], v8 offset:0
    ds_read_b128 v[36:39], v8 offset:1024
    ds_read_b32 v64, v9 offset:0
    ds_read_b128 v[40:43], v8 offset:16384
    ds_read_b128 v[44:47], v8 offset:17408
    ds_read_b32 v65, v9 offset:16384
    ds_read_b128 v[48:51], v8 offset:32768
    ds_read_b128 v[52:55], v8 offset:33792
    ds_read_b32 v66, v9 offset:32768
    ds_read_b128 v[56:59], v8 offset:49152
    ds_read_b128 v[60:63], v8 offset:50176
    ds_read_b32 v67, v9 offset:49152
    s_waitcnt lgkmcnt(0)
    v_add_f32 v32, v32, v40
    v_add_f32 v33, v33, v41
    v_add_f32 v34, v34, v42
    v_add_f32 v35, v35, v43
    v_add_f32 v36, v36, v44
    v_add_f32 v37, v37, v45
    v_add_f32 v38, v38, v46
    v_add_f32 v39, v39, v47
    v_add_f32 v64, v64, v65
    v_add_f32 v32, v32, v48
    v_add_f32 v33, v33, v49
    v_add_f32 v34, v34, v50
    v_add_f32 v35, v35, v51
    v_add_f32 v36, v36, v52
    v_add_f32 v37, v37, v53
    v_add_f32 v38, v38, v54
    v_add_f32 v39, v39, v55
    v_add_f32 v64, v64, v66
    v_add_f32 v32, v32, v56
    v_add_f32 v33, v33, v57
    v_add_f32 v34, v34, v58
    v_add_f32 v35, v35, v59
    v_add_f32 v36, v36, v60
    v_add_f32 v37, v37, v61
    v_add_f32 v38, v38, v62
    v_add_f32 v39, v39, v63
    v_add_f32 v64, v64, v67
    v_rcp_f32 v65, v64
    v_mov_b32 v66, 0x17800000
    v_cmp_nge_f32 vcc, v64, v66
    v_mov_b32 v66, 0x71800000
    v_cmp_nle_f32 s[38:39], v64, v66
    v_mul_f32 v32, v32, v65
    v_mul_f32 v33, v33, v65
    v_mul_f32 v34, v34, v65
    v_mul_f32 v35, v35, v65
    v_mul_f32 v36, v36, v65
    v_mul_f32 v37, v37, v65
    v_mul_f32 v38, v38, v65
    v_mul_f32 v39, v39, v65
    v_cvt_pk_bf16_f32 v40, v32, v33
    v_cvt_pk_bf16_f32 v41, v34, v35
    v_cvt_pk_bf16_f32 v42, v36, v37
    v_cvt_pk_bf16_f32 v43, v38, v39
    s_add_u32 s41, s25, s34
    s_lshl_b32 s41, s41, 5
    s_lshl_b32 s42, s22, 1
    s_add_u32 s41, s41, s42
    s_add_u32 s41, s41, s35
    s_lshl_b32 s41, s41, 10
    s_add_u32 s41, s41, s14
    s_add_u32 s41, s41, 0x1680000
    buffer_store_dwordx4 v[40:43], v5, s[4:7], s41 offen sc1
    s_or_b64 vcc, vcc, s[38:39]
    s_cbranch_vccz ok_34
    v_mov_b32 v8, 1
    v_mov_b32 v9, 159744
    ds_write_b32 v9, v8
ok_34:
    s_waitcnt vmcnt(0) lgkmcnt(0)
    s_barrier
    v_mov_b32 v9, 159744
    ds_read_b32 v8, v9
    s_waitcnt lgkmcnt(0)
    s_nop 0
    v_readfirstlane_b32 s43, v8
    s_cmp_eq_u32 s43, 0
    s_cbranch_scc1 fin_33
    s_cmp_lg_u32 s40, 0
    s_cbranch_scc1 fin_33
    s_mov_b32 s40, 1
    v_mov_b32 v66, 0xff800000
    v_mov_b32 v67, 0xff800000
    s_mov_b32 s44, 0
mx_35:
    s_lshl_b32 s45, s44, 12
    s_add_u32 s45, s45, s29
    buffer_load_dwordx4 v[32:35], v5, s[4:7], s45 offen
    buffer_load_dwordx4 v[36:39], v5, s[4:7], s45 offen offset:1024
    s_waitcnt vmcnt(0)
    v_mfma_f32_32x32x16_bf16 v[128:143], v[32:35], v[16:19], 0
    v_mfma_f32_32x32x16_bf16 v[128:143], v[36:39], v[20:23], v[128:143]
    v_mfma_f32_32x32x16_bf16 v[144:159], v[32:35], v[24:27], 0
    v_mfma_f32_32x32x16_bf16 v[144:159], v[36:39], v[28:31], v[144:159]
    s_nop 15
    s_nop 3
    v_max3_f32 v66, v66, v128, v129
    v_max3_f32 v66, v66, v130, v131
    v_max3_f32 v66, v66, v132, v133
    v_max3_f32 v66, v66, v134, v135
    v_max3_f32 v66, v66, v136, v137
    v_max3_f32 v66, v66, v138, v139
    v_max3_f32 v66, v66, v140, v141
    v_max3_f32 v66, v66, v142, v143
    v_max3_f32 v67, v67, v144, v145
    v_max3_f32 v67, v67, v146, v147
    v_max3_f32 v67, v67, v148, v149
    v_max3_f32 v67, v67, v150, v151
    v_max3_f32 v67, v67, v152, v153
    v_max3_f32 v67, v67, v154, v155
    v_max3_f32 v67, v67, v156, v157
    v_max3_f32 v67, v67, v158, v159
    s_add_u32 s44, s44, 1
    s_cmp_lt_u32 s44, 16
    s_cbranch_scc1 mx_35
    v_mov_b32 v68, v66
    s_nop 1
    v_permlane32_swap_b32 v66, v68
    s_nop 0
    v_max_f32 v66, v66, v68
    v_mov_b32 v68, v67
    s_nop 1
    v_permlane32_swap_b32 v67, v68
    s_nop 0
    v_max_f32 v67, v67, v68
    s_lshl_b32 s45, s3, 8
    s_add_u32 s45, s45, 159808
    v_lshlrev_b32 v8, 2, v4
    v_add_u32 v9, s45, v8
    ds_write_b32 v9, v66
    ds_write_b32 v9, v67 offset:128
    s_waitcnt lgkmcnt(0)
    s_barrier
    s_lshl_b32 s45, s23, 8
    s_add_u32 s45, s45, 159808
    v_add_u32 v9, s45, v8
    ds_read_b32 v32, v9 offset:0
    ds_read_b32 v33, v9 offset:128
    ds_read_b32 v34, v9 offset:512
    ds_read_b32 v35, v9 offset:640
    ds_read_b32 v36, v9 offset:1024
    ds_read_b32 v37, v9 offset:1152
    ds_read_b32 v38, v9 offset:1536
    ds_read_b32 v39, v9 offset:1664
    v_mov_b32 v8, 0
    v_mov_b32 v10, 159744
    ds_write_b32 v10, v8
    s_waitcnt lgkmcnt(0)
    v_max3_f32 v32, v32, v34, v36
    v_max_f32 v32, v32, v38
    v_add_f32 v14, v14, v32
    v_cvt_pk_bf16_f32 v8, v14, v14
    v_and_b32 v8, 0xffff0000, v8
    v_sub_f32 v9, v14, v8
    v_cvt_pk_bf16_f32 v10, v9, v9
    v_and_b32 v10, 0xffff0000, v10
    v_add_f32 v14, v8, v10
    v_cvt_pk_bf16_f32 v9, -v8, -v10
    s_mov_b32 exec_lo, 0
    v_mov_b32 v22, v9
    s_mov_b32 exec_lo, -1
    v_max3_f32 v33, v33, v35, v37
    v_max_f32 v33, v33, v39
    v_add_f32 v15, v15, v33
    v_cvt_pk_bf16_f32 v8, v15, v15
    v_and_b32 v8, 0xffff0000, v8
    v_sub_f32 v9, v15, v8
    v_cvt_pk_bf16_f32 v10, v9, v9
    v_and_b32 v10, 0xffff0000, v10
    v_add_f32 v15, v8, v10
    v_cvt_pk_bf16_f32 v9, -v8, -v10
    s_mov_b32 exec_lo, 0
    v_mov_b32 v30, v9
    s_mov_b32 exec_lo, -1
    s_barrier
    s_add_u32 s31, s29, 0
    buffer_load_dwordx4 v[32:35], v5, s[4:7], s31 offen offset:0
    buffer_load_dwordx4 v[36:39], v5, s[4:7], s31 offen offset:1024
    buffer_load_dwordx4 v[40:43], v5, s[4:7], s31 offen offset:2048
    buffer_load_dwordx4 v[44:47], v5, s[4:7], s31 offen offset:3072
    s_add_u32 s31, s29, 4096
    buffer_load_dwordx4 v[48:51], v5, s[4:7], s31 offen offset:0
    buffer_load_dwordx4 v[52:55], v5, s[4:7], s31 offen offset:1024
    buffer_load_dwordx4 v[56:59], v5, s[4:7], s31 offen offset:2048
    buffer_load_dwordx4 v[60:63], v5, s[4:7], s31 offen offset:3072
    s_add_u32 s31, s29, 8192
    buffer_load_dwordx4 v[64:67], v5, s[4:7], s31 offen offset:0
    buffer_load_dwordx4 v[68:71], v5, s[4:7], s31 offen offset:1024
    buffer_load_dwordx4 v[72:75], v5, s[4:7], s31 offen offset:2048
    buffer_load_dwordx4 v[76:79], v5, s[4:7], s31 offen offset:3072
    s_add_u32 s31, s29, 12288
    buffer_load_dwordx4 v[80:83], v5, s[4:7], s31 offen offset:0
    buffer_load_dwordx4 v[84:87], v5, s[4:7], s31 offen offset:1024
    buffer_load_dwordx4 v[88:91], v5, s[4:7], s31 offen offset:2048
    buffer_load_dwordx4 v[92:95], v5, s[4:7], s31 offen offset:3072
    s_branch main_32
fin_33:
    s_setprio 0
    s_lshl_b32 s24, s21, 7
    s_lshl_b32 s25, s22, 2
    s_add_u32 s24, s24, s25
    s_add_u32 s24, s24, s16
    s_add_u32 s24, s24, 2048
    s_cmp_lg_u32 s3, 0
    s_cbranch_scc1 pb_36
    s_mov_b32 exec_lo, 1
    s_mov_b32 exec_hi, 0
    v_mov_b32 v9, 1
    buffer_store_dword v9, off, s[4:7], s24 sc1
    s_mov_b32 exec_lo, -1
    s_mov_b32 exec_hi, -1
pb_36:
    s_cmp_ge_u32 s13, 28
    s_cbranch_scc1 idle_14
    s_and_b32 s56, s3, 3
    s_lshr_b32 s57, s3, 2
    s_lshl_b32 s58, s50, 1
    s_add_u32 s58, s58, s57
    s_lshl_b32 s59, s51, 2
    s_add_u32 s59, s59, s56
    s_cmp_eq_u32 s3, 0
    s_cbranch_scc1 w0_37
    s_mul_i32 s30, s51, 224
    s_mul_i32 s60, s56, 28
    s_add_u32 s30, s30, s60
    s_lshl_b32 s30, s30, 10
    s_add_u32 s30, s30, 0xd00000
    s_add_u32 s31, s30, 114688
    s_add_u32 s36, s30, 0
    buffer_load_dwordx4 v[128:131], v5, s[4:7], s36 offen offset:0
    s_add_u32 s37, s31, 0
    buffer_load_dwordx4 v[132:135], v5, s[4:7], s37 offen offset:0
    buffer_load_dwordx4 v[136:139], v5, s[4:7], s36 offen offset:1024
    buffer_load_dwordx4 v[140:143], v5, s[4:7], s37 offen offset:1024
    buffer_load_dwordx4 v[144:147], v5, s[4:7], s36 offen offset:2048
    buffer_load_dwordx4 v[148:151], v5, s[4:7], s37 offen offset:2048
    buffer_load_dwordx4 v[152:155], v5, s[4:7], s36 offen offset:3072
    buffer_load_dwordx4 v[156:159], v5, s[4:7], s37 offen offset:3072
    s_add_u32 s36, s30, 4096
    buffer_load_dwordx4 v[160:163], v5, s[4:7], s36 offen offset:0
    s_add_u32 s37, s31, 4096
    buffer_load_dwordx4 v[164:167], v5, s[4:7], s37 offen offset:0
    buffer_load_dwordx4 v[168:171], v5, s[4:7], s36 offen offset:1024
    buffer_load_dwordx4 v[172:175], v5, s[4:7], s37 offen offset:1024
w0_37:
    s_lshr_b32 s24, s50, 1
    s_lshl_b32 s24, s24, 7
    s_add_u32 s24, s24, s16
    s_add_u32 s24, s24, 2048
    s_lshl_b32 s25, s56, 13
    s_add_u32 s25, s25, 69632
    v_add_u32 v12, s25, v5
    ds_read_b128 v[48:51], v12 offset:0
    ds_read_b128 v[52:55], v12 offset:32768
    ds_read_b128 v[56:59], v12 offset:1024
    ds_read_b128 v[60:63], v12 offset:33792
    s_lshl_b32 s26, s58, 5
    s_lshl_b32 s27, s56, 3
    s_add_u32 s26, s26, s27
    s_lshl_b32 s26, s26, 10
    s_add_u32 s26, s26, s14
    s_add_u32 s26, s26, 0x1680000
    s_add_u32 s27, s26, 4096
    s_cmp_lg_u32 s3, 0
    s_cbranch_scc1 pl_39
    s_mov_b32 exec_lo, 0xffff
    s_mov_b32 exec_hi, 0
    v_lshlrev_b32 v8, 2, v1
    s_mov_b32 s18, 0
    buffer_load_dword v16, v8, s[4:7], s24 offen sc1
    s_sleep 1
    buffer_load_dword v17, v8, s[4:7], s24 offen sc1
    s_sleep 1
    buffer_load_dword v18, v8, s[4:7], s24 offen sc1
pl_38:
    s_waitcnt vmcnt(2)
    v_cmp_eq_u32 vcc, 0, v16
    s_add_u32 s18, s18, 1
    s_nop 0
    s_cmp_eq_u32 vcc_lo, 0
    s_cbranch_scc1 pl_40
    buffer_load_dword v16, v8, s[4:7], s24 offen sc1
    s_waitcnt vmcnt(2)
    v_cmp_eq_u32 vcc, 0, v17
    s_add_u32 s18, s18, 1
    s_nop 0
    s_cmp_eq_u32 vcc_lo, 0
    s_cbranch_scc1 pl_40
    buffer_load_dword v17, v8, s[4:7], s24 offen sc1
    s_waitcnt vmcnt(2)
    v_cmp_eq_u32 vcc, 0, v18
    s_add_u32 s18, s18, 1
    s_nop 0
    s_cmp_eq_u32 vcc_lo, 0
    s_cbranch_scc1 pl_40
    buffer_load_dword v18, v8, s[4:7], s24 offen sc1
    s_cmp_lt_u32 s18, 32768
    s_cbranch_scc1 pl_38
pl_40:
    s_mov_b32 exec_lo, -1
    s_mov_b32 exec_hi, -1
pl_39:
    s_barrier
    buffer_load_dwordx4 v[16:19], v5, s[4:7], s26 offen offset:0 sc1
    buffer_load_dwordx4 v[20:23], v5, s[4:7], s26 offen offset:1024 sc1
    buffer_load_dwordx4 v[24:27], v5, s[4:7], s26 offen offset:2048 sc1
    buffer_load_dwordx4 v[28:31], v5, s[4:7], s26 offen offset:3072 sc1
    buffer_load_dwordx4 v[32:35], v5, s[4:7], s27 offen offset:0 sc1
    buffer_load_dwordx4 v[36:39], v5, s[4:7], s27 offen offset:1024 sc1
    buffer_load_dwordx4 v[40:43], v5, s[4:7], s27 offen offset:2048 sc1
    buffer_load_dwordx4 v[44:47], v5, s[4:7], s27 offen offset:3072 sc1
    s_waitcnt vmcnt(7)
    s_waitcnt lgkmcnt(2)
    v_mfma_f32_32x32x16_bf16 v[64:79], v[48:51], v[16:19], 0
    v_mfma_f32_32x32x16_bf16 v[80:95], v[52:55], v[16:19], 0
    ds_read_b128 v[48:51], v12 offset:2048
    ds_read_b128 v[52:55], v12 offset:34816
    s_waitcnt vmcnt(6)
    s_waitcnt lgkmcnt(2)
    v_mfma_f32_32x32x16_bf16 v[64:79], v[56:59], v[20:23], v[64:79]
    v_mfma_f32_32x32x16_bf16 v[80:95], v[60:63], v[20:23], v[80:95]
    ds_read_b128 v[56:59], v12 offset:3072
    ds_read_b128 v[60:63], v12 offset:35840
    s_waitcnt vmcnt(5)
    s_waitcnt lgkmcnt(2)
    v_mfma_f32_32x32x16_bf16 v[64:79], v[48:51], v[24:27], v[64:79]
    v_mfma_f32_32x32x16_bf16 v[80:95], v[52:55], v[24:27], v[80:95]
    ds_read_b128 v[48:51], v12 offset:4096
    ds_read_b128 v[52:55], v12 offset:36864
    s_waitcnt vmcnt(4)
    s_waitcnt lgkmcnt(2)
    v_mfma_f32_32x32x16_bf16 v[64:79], v[56:59], v[28:31], v[64:79]
    v_mfma_f32_32x32x16_bf16 v[80:95], v[60:63], v[28:31], v[80:95]
    ds_read_b128 v[56:59], v12 offset:5120
    ds_read_b128 v[60:63], v12 offset:37888
    s_waitcnt vmcnt(3)
    s_waitcnt lgkmcnt(2)
    v_mfma_f32_32x32x16_bf16 v[64:79], v[48:51], v[32:35], v[64:79]
    v_mfma_f32_32x32x16_bf16 v[80:95], v[52:55], v[32:35], v[80:95]
    ds_read_b128 v[48:51], v12 offset:6144
    ds_read_b128 v[52:55], v12 offset:38912
    s_waitcnt vmcnt(2)
    s_waitcnt lgkmcnt(2)
    v_mfma_f32_32x32x16_bf16 v[64:79], v[56:59], v[36:39], v[64:79]
    v_mfma_f32_32x32x16_bf16 v[80:95], v[60:63], v[36:39], v[80:95]
    ds_read_b128 v[56:59], v12 offset:7168
    ds_read_b128 v[60:63], v12 offset:39936
    s_waitcnt vmcnt(1)
    s_waitcnt lgkmcnt(2)
    v_mfma_f32_32x32x16_bf16 v[64:79], v[48:51], v[40:43], v[64:79]
    v_mfma_f32_32x32x16_bf16 v[80:95], v[52:55], v[40:43], v[80:95]
    s_waitcnt vmcnt(0)
    s_waitcnt lgkmcnt(0)
    v_mfma_f32_32x32x16_bf16 v[64:79], v[56:59], v[44:47], v[64:79]
    v_mfma_f32_32x32x16_bf16 v[80:95], v[60:63], v[44:47], v[80:95]
    s_mul_i32 s60, s58, 28
    s_add_u32 s60, s60, s59
    s_lshl_b32 s60, s60, 10
    s_add_u32 s60, s60, s14
    s_add_u32 s60, s60, 0x1000000
    buffer_load_dwordx4 v[48:51], v5, s[4:7], s60 offen sc1
    s_cmp_lg_u32 s3, 0
    s_cbranch_scc1 w1_41
    s_mul_i32 s30, s51, 224
    s_mul_i32 s60, s56, 28
    s_add_u32 s30, s30, s60
    s_lshl_b32 s30, s30, 10
    s_add_u32 s30, s30, 0xd00000
    s_add_u32 s31, s30, 114688
    s_add_u32 s36, s30, 0
    buffer_load_dwordx4 v[128:131], v5, s[4:7], s36 offen offset:0
    s_add_u32 s37, s31, 0
    buffer_load_dwordx4 v[132:135], v5, s[4:7], s37 offen offset:0
    buffer_load_dwordx4 v[136:139], v5, s[4:7], s36 offen offset:1024
    buffer_load_dwordx4 v[140:143], v5, s[4:7], s37 offen offset:1024
    buffer_load_dwordx4 v[144:147], v5, s[4:7], s36 offen offset:2048
    buffer_load_dwordx4 v[148:151], v5, s[4:7], s37 offen offset:2048
    buffer_load_dwordx4 v[152:155], v5, s[4:7], s36 offen offset:3072
    buffer_load_dwordx4 v[156:159], v5, s[4:7], s37 offen offset:3072
    s_add_u32 s36, s30, 4096
    buffer_load_dwordx4 v[160:163], v5, s[4:7], s36 offen offset:0
    s_add_u32 s37, s31, 4096
    buffer_load_dwordx4 v[164:167], v5, s[4:7], s37 offen offset:0
    buffer_load_dwordx4 v[168:171], v5, s[4:7], s36 offen offset:1024
    buffer_load_dwordx4 v[172:175], v5, s[4:7], s37 offen offset:1024
w1_41:
    s_nop 15
    s_lshl_b32 s60, s57, 15
    v_add_u32 v8, s60, v5
    s_cmp_eq_u32 s56, 1
    s_cbranch_scc1 ro_43
    s_cmp_eq_u32 s56, 2
    s_cbranch_scc1 ro_44
    s_cmp_eq_u32 s56, 3
    s_cbranch_scc1 ro_45
ro_42:
    ds_write_b128 v8, v[72:75] offset:12288
    ds_write_b128 v8, v[76:79] offset:13312
    ds_write_b128 v8, v[80:83] offset:18432
    ds_write_b128 v8, v[84:87] offset:19456
    ds_write_b128 v8, v[88:91] offset:24576
    ds_write_b128 v8, v[92:95] offset:25600
    v_mov_b32 v40, v64
    v_mov_b32 v41, v65
    v_mov_b32 v42, v66
    v_mov_b32 v43, v67
    v_mov_b32 v44, v68
    v_mov_b32 v45, v69
    v_mov_b32 v46, v70
    v_mov_b32 v47, v71
    s_branch ro_46
ro_43:
    ds_write_b128 v8, v[64:67] offset:0
    ds_write_b128 v8, v[68:71] offset:1024
    ds_write_b128 v8, v[80:83] offset:20480
    ds_write_b128 v8, v[84:87] offset:21504
    ds_write_b128 v8, v[88:91] offset:26624
    ds_write_b128 v8, v[92:95] offset:27648
    v_mov_b32 v40, v72
    v_mov_b32 v41, v73
    v_mov_b32 v42, v74
    v_mov_b32 v43, v75
    v_mov_b32 v44, v76
    v_mov_b32 v45, v77
    v_mov_b32 v46, v78
    v_mov_b32 v47, v79
    s_branch ro_46
ro_44:
    ds_write_b128 v8, v[64:67] offset:2048
    ds_write_b128 v8, v[68:71] offset:3072
    ds_write_b128 v8, v[72:75] offset:8192
    ds_write_b128 v8, v[76:79] offset:9216
    ds_write_b128 v8, v[88:91] offset:28672
    ds_write_b128 v8, v[92:95] offset:29696
    v_mov_b32 v40, v80
    v_mov_b32 v41, v81
    v_mov_b32 v42, v82
    v_mov_b32 v43, v83
    v_mov_b32 v44, v84
    v_mov_b32 v45, v85
    v_mov_b32 v46, v86
    v_mov_b32 v47, v87
    s_branch ro_46
ro_45:
    ds_write_b128 v8, v[64:67] offset:4096
    ds_write_b128 v8, v[68:71] offset:5120
    ds_write_b128 v8, v[72:75] offset:10240
    ds_write_b128 v8, v[76:79] offset:11264
    ds_write_b128 v8, v[80:83] offset:16384
    ds_write_b128 v8, v[84:87] offset:17408
    v_mov_b32 v40, v88
    v_mov_b32 v41, v89
    v_mov_b32 v42, v90
    v_mov_b32 v43, v91
    v_mov_b32 v44, v92
    v_mov_b32 v45, v93
    v_mov_b32 v46, v94
    v_mov_b32 v47, v95
ro_46:
    s_lshl_b32 s61, s56, 13
    s_add_u32 s61, s61, s60
    v_add_u32 v9, s61, v5
    s_mul_i32 s62, s58, 28
    s_add_u32 s62, s62, s59
    s_lshl_b32 s62, s62, 10
    s_add_u32 s62, s62, s14
    s_add_u32 s62, s62, 0x12c0000
    s_lshr_b32 s63, s59, 1
    s_mul_i32 s60, s58, 14
    s_add_u32 s63, s63, s60
    s_lshl_b32 s63, s63, 9
    s_and_b32 s60, s59, 1
    s_lshl_b32 s60, s60, 3
    s_add_u32 s63, s63, s60
    s_add_u32 s63, s63, s14
    s_add_u32 s63, s63, 0x1230000
    s_waitcnt lgkmcnt(0)
    s_barrier
    ds_read_b128 v[16:19], v9 offset:0
    ds_read_b128 v[20:23], v9 offset:1024
    ds_read_b128 v[24:27], v9 offset:2048
    ds_read_b128 v[28:31], v9 offset:3072
    ds_read_b128 v[32:35], v9 offset:4096
    ds_read_b128 v[36:39], v9 offset:5120
    s_cmp_eq_u32 s3, 0
    s_cbranch_scc1 rw_47
    s_waitcnt vmcnt(0)
    s_branch rw_48
rw_47:
    s_waitcnt vmcnt(12)
rw_48:
    v_lshlrev_b32 v64, 16, v48
    v_and_b32 v65, 0xffff0000, v48
    v_lshlrev_b32 v66, 16, v49
    v_and_b32 v67, 0xffff0000, v49
    v_lshlrev_b32 v68, 16, v50
    v_and_b32 v69, 0xffff0000, v50
    v_lshlrev_b32 v70, 16, v51
    v_and_b32 v71, 0xffff0000, v51
    v_add_f32 v64, v64, v40
    v_add_f32 v65, v65, v41
    v_add_f32 v66, v66, v42
    v_add_f32 v67, v67, v43
    v_add_f32 v68, v68, v44
    v_add_f32 v69, v69, v45
    v_add_f32 v70, v70, v46
    v_add_f32 v71, v71, v47
    s_waitcnt lgkmcnt(4)
    v_add_f32 v64, v64, v16
    v_add_f32 v65, v65, v17
    v_add_f32 v66, v66, v18
    v_add_f32 v67, v67, v19
    v_add_f32 v68, v68, v20
    v_add_f32 v69, v69, v21
    v_add_f32 v70, v70, v22
    v_add_f32 v71, v71, v23
    s_waitcnt lgkmcnt(2)
    v_add_f32 v64, v64, v24
    v_add_f32 v65, v65, v25
    v_add_f32 v66, v66, v26
    v_add_f32 v67, v67, v27
    v_add_f32 v68, v68, v28
    v_add_f32 v69, v69, v29
    v_add_f32 v70, v70, v30
    v_add_f32 v71, v71, v31
    s_waitcnt lgkmcnt(0)
    v_add_f32 v64, v64, v32
    v_add_f32 v65, v65, v33
    v_add_f32 v66, v66, v34
    v_add_f32 v67, v67, v35
    v_add_f32 v68, v68, v36
    v_add_f32 v69, v69, v37
    v_add_f32 v70, v70, v38
    v_add_f32 v71, v71, v39
    v_cvt_pk_bf16_f32 v16, v64, v65
    v_cvt_pk_bf16_f32 v17, v66, v67
    v_cvt_pk_bf16_f32 v18, v68, v69
    v_cvt_pk_bf16_f32 v19, v70, v71
    s_cmp_eq_u32 s48, 0
    s_cbranch_scc1 hs_51
    buffer_store_dwordx4 v[16:19], v5, s[4:7], s62 offen
    s_branch hs_52
hs_51:
    buffer_store_dwordx4 v[16:19], v5, s[4:7], s62 offen sc1
hs_52:
    v_add_f32 v8, v64, v65
    v_mul_f32 v9, v64, v64
    v_fmac_f32 v9, v65, v65
    v_add_f32 v10, v66, v67
    v_mul_f32 v11, v66, v66
    v_fmac_f32 v11, v67, v67
    v_add_f32 v8, v8, v68
    v_fmac_f32 v9, v68, v68
    v_add_f32 v10, v10, v69
    v_fmac_f32 v11, v69, v69
    v_add_f32 v8, v8, v70
    v_fmac_f32 v9, v70, v70
    v_add_f32 v10, v10, v71
    v_fmac_f32 v11, v71, v71
    v_add_f32 v8, v8, v10
    v_add_f32 v9, v9, v11
    v_mov_b32 v10, v8
    s_nop 1
    v_permlane32_swap_b32 v8, v10
    s_nop 0
    v_add_f32 v8, v8, v10
    v_mov_b32 v10, v9
    s_nop 1
    v_permlane32_swap_b32 v9, v10
    s_nop 0
    v_add_f32 v9, v9, v10
    v_lshlrev_b32 v10, 4, v4
    s_mov_b32 exec_hi, 0
    s_cmp_eq_u32 s48, 0
    s_cbranch_scc1 hs_53
    buffer_store_dwordx2 v[8:9], v10, s[4:7], s63 offen
    s_branch hs_54
hs_53:
    buffer_store_dwordx2 v[8:9], v10, s[4:7], s63 offen sc1
hs_54:
    s_mov_b32 exec_hi, -1
    s_lshl_b32 s24, s50, 7
    s_lshl_b32 s25, s51, 2
    s_add_u32 s24, s24, s25
    s_add_u32 s24, s24, s16
    s_add_u32 s24, s24, 4096
    s_waitcnt vmcnt(0)
    s_barrier
    s_cmp_lg_u32 s3, 0
    s_cbranch_scc1 pb_55
    s_mov_b32 exec_lo, 1
    s_mov_b32 exec_hi, 0
    v_mov_b32 v9, 1
    s_cmp_eq_u32 s17, 0
    s_cbranch_scc1 hs_56
    buffer_store_dword v9, off, s[4:7], s24
    s_branch hs_57
hs_56:
    buffer_store_dword v9, off, s[4:7], s24 sc1
hs_57:
    s_mov_b32 exec_lo, -1
    s_mov_b32 exec_hi, -1
pb_55:
    s_lshl_b32 s24, s50, 7
    s_add_u32 s24, s24, s16
    s_add_u32 s24, s24, 4096
    s_lshl_b32 s25, s51, 3
    s_add_u32 s25, s25, s3
    s_lshl_b32 s26, s25, 8
    s_add_u32 s26, s26, 0xf10000
    s_lshl_b32 s27, s3, 8
    s_add_u32 m0, s27, 57344
    s_mov_b32 exec_lo, 0xffff
    s_mov_b32 exec_hi, 0
    buffer_load_dwordx4 v5, s[4:7], s26 offen lds
    s_mov_b32 exec_lo, -1
    s_mov_b32 exec_hi, -1
    s_mul_i32 s28, s50, 57344
    s_lshl_b32 s29, s3, 10
    s_add_u32 s28, s28, s29
    s_add_u32 s28, s28, s14
    s_add_u32 s28, s28, 0x12c0000
    s_mul_i32 s30, s51, 224
    s_mul_i32 s60, s56, 28
    s_add_u32 s30, s30, s60
    s_lshl_b32 s30, s30, 10
    s_add_u32 s30, s30, 0xd00000
    s_add_u32 s31, s30, 114688
    s_mul_i32 s32, s57, 114688
    s_add_u32 s32, s32, s30
    s_mul_i32 s33, s56, 24576
    s_lshl_b32 s34, s57, 10
    s_add_u32 s33, s33, s34
    s_add_u32 s33, s33, 65536
    s_mul_i32 s35, s56, 12288
    s_add_u32 s35, s35, s34
    s_cmp_lg_u32 s3, 0
    s_cbranch_scc1 pl_59
    s_mov_b32 exec_lo, 0x7f
    s_mov_b32 exec_hi, 0
    v_lshlrev_b32 v8, 2, v1
    s_mov_b32 s18, 0
    buffer_load_dword v60, v8, s[4:7], s24 offen sc1
    s_sleep 1
    buffer_load_dword v61, v8, s[4:7], s24 offen sc1
    s_sleep 1
    buffer_load_dword v62, v8, s[4:7], s24 offen sc1
pl_58:
    s_waitcnt vmcnt(2)
    v_cmp_eq_u32 vcc, 0, v60
    s_add_u32 s18, s18, 1
    s_nop 0
    s_cmp_eq_u32 vcc_lo, 0
    s_cbranch_scc1 pl_60
    buffer_load_dword v60, v8, s[4:7], s24 offen sc1
    s_waitcnt vmcnt(2)
    v_cmp_eq_u32 vcc, 0, v61
    s_add_u32 s18, s18, 1
    s_nop 0
    s_cmp_eq_u32 vcc_lo, 0
    s_cbranch_scc1 pl_60
    buffer_load_dword v61, v8, s[4:7], s24 offen sc1
    s_waitcnt vmcnt(2)
    v_cmp_eq_u32 vcc, 0, v62
    s_add_u32 s18, s18, 1
    s_nop 0
    s_cmp_eq_u32 vcc_lo, 0
    s_cbranch_scc1 pl_60
    buffer_load_dword v62, v8, s[4:7], s24 offen sc1
    s_cmp_lt_u32 s18, 32768
    s_cbranch_scc1 pl_58
pl_60:
    s_mov_b32 exec_lo, -1
    s_mov_b32 exec_hi, -1
pl_59:
    s_barrier
    s_cmp_ge_u32 s3, 2
    s_cbranch_scc1 fs_61
    s_lshl_b32 s37, s50, 1
    s_add_u32 s37, s37, s3
    s_mul_i32 s37, s37, 7168
    s_add_u32 s37, s37, s14
    s_add_u32 s37, s37, 0x1230000
    v_mul_u32_u24 v0, 3584, v3
    v_lshl_add_u32 v0, v4, 4, v0
    buffer_load_dwordx4 v[32:35], v0, s[4:7], s37 offen offset:0 sc1
    buffer_load_dwordx4 v[36:39], v0, s[4:7], s37 offen offset:512 sc1
    buffer_load_dwordx4 v[40:43], v0, s[4:7], s37 offen offset:1024 sc1
    buffer_load_dwordx4 v[44:47], v0, s[4:7], s37 offen offset:1536 sc1
    buffer_load_dwordx4 v[48:51], v0, s[4:7], s37 offen offset:2048 sc1
    buffer_load_dwordx4 v[52:55], v0, s[4:7], s37 offen offset:2560 sc1
    buffer_load_dwordx4 v[56:59], v0, s[4:7], s37 offen offset:3072 sc1
fs_61:
    s_add_u32 s36, s28, 0
    buffer_load_dwordx4 v[60:63], v5, s[4:7], s36 offen sc1
    s_add_u32 s36, s28, 8192
    buffer_load_dwordx4 v[64:67], v5, s[4:7], s36 offen sc1
    s_add_u32 s36, s28, 16384
    buffer_load_dwordx4 v[68:71], v5, s[4:7], s36 offen sc1
    s_add_u32 s36, s28, 24576
    buffer_load_dwordx4 v[72:75], v5, s[4:7], s36 offen sc1
    s_add_u32 s36, s28, 32768
    buffer_load_dwordx4 v[76:79], v5, s[4:7], s36 offen sc1
    s_add_u32 s36, s28, 40960
    buffer_load_dwordx4 v[80:83], v5, s[4:7], s36 offen sc1
    s_add_u32 s36, s28, 49152
    buffer_load_dwordx4 v[84:87], v5, s[4:7], s36 offen sc1
    v_add_u32 v15, s29, v5
    s_mul_i32 s38, s50, 224
    s_lshl_b32 s39, s25, 1
    s_add_u32 s38, s38, s39
    s_lshl_b32 s38, s38, 10
    s_add_u32 s38, s38, s14
    s_add_u32 s38, s38, 0x2080000
    s_add_u32 s39, s38, 114688
    v_mov_b32 v12, 0xbfb17218
    v_mov_b32 v13, 0x3f317218
    v_lshlrev_b32 v14, 6, v3
    v_add_u32 v14, 57344, v14
    v_add_u32 v14, s27, v14
    s_cmp_ge_u32 s3, 2
    s_cbranch_scc1 fq_62
    s_waitcnt vmcnt(7)
fq_62:
    s_cmp_ge_u32 s3, 2
    s_cbranch_scc1 fs_63
    v_add_f32 v32, v32, v36
    v_add_f32 v33, v33, v37
    v_add_f32 v34, v34, v38
    v_add_f32 v35, v35, v39
    v_add_f32 v32, v32, v40
    v_add_f32 v33, v33, v41
    v_add_f32 v34, v34, v42
    v_add_f32 v35, v35, v43
    v_add_f32 v32, v32, v44
    v_add_f32 v33, v33, v45
    v_add_f32 v34, v34, v46
    v_add_f32 v35, v35, v47
    v_add_f32 v32, v32, v48
    v_add_f32 v33, v33, v49
    v_add_f32 v34, v34, v50
    v_add_f32 v35, v35, v51
    v_add_f32 v32, v32, v52
    v_add_f32 v33, v33, v53
    v_add_f32 v34, v34, v54
    v_add_f32 v35, v35, v55
    v_add_f32 v32, v32, v56
    v_add_f32 v33, v33, v57
    v_add_f32 v34, v34, v58
    v_add_f32 v35, v35, v59
    v_add_f32 v32, v32, v34
    v_add_f32 v33, v33, v35
    v_mov_b32 v10, v32
    s_nop 1
    v_permlane32_swap_b32 v32, v10
    s_nop 0
    v_add_f32 v32, v32, v10
    v_mov_b32 v10, v33
    s_nop 1
    v_permlane32_swap_b32 v33, v10
    s_nop 0
    v_add_f32 v33, v33, v10
    v_mul_f32 v32, 0x3b124925, v32
    v_mul_f32 v33, 0x3b124925, v33
    v_fma_f32 v33, -v32, v32, v33
    v_max_f32 v33, 0, v33
    v_add_f32 v33, 0x3727c5ac, v33
    v_rsq_f32 v8, v33
    s_nop 0
    v_mul_f32 v9, v32, v8
    v_sub_f32 v9, 0, v9
    v_mul_f32 v8, 0x3fb8aa3b, v8
    s_lshl_b32 s37, s3, 8
    s_add_u32 s37, s37, 59392
    v_lshlrev_b32 v10, 3, v4
    v_add_u32 v10, s37, v10
    ds_write_b64 v10, v[8:9]
fs_63:
    s_waitcnt vmcnt(6)
    ds_write_b128 v15, v[60:63] offset:0
    s_waitcnt vmcnt(5)
    ds_write_b128 v15, v[64:67] offset:8192
    s_waitcnt vmcnt(4)
    ds_write_b128 v15, v[68:71] offset:16384
    s_waitcnt vmcnt(3)
    ds_write_b128 v15, v[72:75] offset:24576
    s_waitcnt vmcnt(2)
    ds_write_b128 v15, v[76:79] offset:32768
    s_waitcnt vmcnt(1)
    ds_write_b128 v15, v[80:83] offset:40960
    s_waitcnt vmcnt(0)
    ds_write_b128 v15, v[84:87] offset:49152
    s_waitcnt lgkmcnt(0)
    s_barrier
    s_sub_u32 s33, s33, s34
    s_cmp_ge_u32 s3, 4
    s_cbranch_scc1 fb_64
    ds_read_b128 v[80:83], v5 offset:0
    ds_read_b128 v[84:87], v5 offset:1024
    ds_read_b128 v[88:91], v5 offset:2048
    s_setprio 1
    ds_read_b128 v[92:95], v5 offset:3072
    s_waitcnt lgkmcnt(3)
    v_mfma_f32_32x32x16_bf16 v[16:31], v[176:179], v[80:83], 0
    ds_read_b128 v[80:83], v5 offset:4096
    s_waitcnt lgkmcnt(3)
    v_mfma_f32_32x32x16_bf16 v[16:31], v[180:183], v[84:87], v[16:31]
    ds_read_b128 v[84:87], v5 offset:5120
    s_waitcnt lgkmcnt(3)
    v_mfma_f32_32x32x16_bf16 v[16:31], v[184:187], v[88:91], v[16:31]
    ds_read_b128 v[88:91], v5 offset:6144
    s_waitcnt lgkmcnt(3)
    v_mfma_f32_32x32x16_bf16 v[16:31], v[188:191], v[92:95], v[16:31]
    ds_read_b128 v[92:95], v5 offset:7168
    s_waitcnt lgkmcnt(3)
    v_mfma_f32_32x32x16_bf16 v[16:31], v[192:195], v[80:83], v[16:31]
    ds_read_b128 v[80:83], v5 offset:8192
    s_waitcnt lgkmcnt(3)
    v_mfma_f32_32x32x16_bf16 v[16:31], v[196:199], v[84:87], v[16:31]
    ds_read_b128 v[84:87], v5 offset:9216
    s_waitcnt lgkmcnt(3)
    v_mfma_f32_32x32x16_bf16 v[16:31], v[200:203], v[88:91], v[16:31]
    ds_read_b128 v[88:91], v5 offset:10240
    s_waitcnt lgkmcnt(3)
    v_mfma_f32_32x32x16_bf16 v[16:31], v[204:207], v[92:95], v[16:31]
    ds_read_b128 v[92:95], v5 offset:11264
    s_waitcnt lgkmcnt(3)
    v_mfma_f32_32x32x16_bf16 v[16:31], v[208:211], v[80:83], v[16:31]
    ds_read_b128 v[80:83], v5 offset:12288
    s_waitcnt lgkmcnt(3)
    v_mfma_f32_32x32x16_bf16 v[16:31], v[212:215], v[84:87], v[16:31]
    ds_read_b128 v[84:87], v5 offset:13312
    s_waitcnt lgkmcnt(3)
    v_mfma_f32_32x32x16_bf16 v[16:31], v[216:219], v[88:91], v[16:31]
    v_lshlrev_b32 v15, 3, v4
    v_add_u32 v15, 59392, v15
    ds_read_b64 v[8:9], v15
    ds_read_b64 v[10:11], v15 offset:256
    ds_read_b128 v[88:91], v5 offset:14336
    s_waitcnt lgkmcnt(5)
    v_mfma_f32_32x32x16_bf16 v[16:31], v[220:223], v[92:95], v[16:31]
    ds_read_b128 v[92:95], v5 offset:15360
    s_waitcnt lgkmcnt(5)
    v_mfma_f32_32x32x16_bf16 v[16:31], v[224:227], v[80:83], v[16:31]
    ds_read_b128 v[80:83], v5 offset:16384
    s_waitcnt lgkmcnt(5)
    v_mfma_f32_32x32x16_bf16 v[16:31], v[228:231], v[84:87], v[16:31]
    ds_read_b128 v[84:87], v5 offset:17408
    s_waitcnt lgkmcnt(3)
    v_mfma_f32_32x32x16_bf16 v[16:31], v[232:235], v[88:91], v[16:31]
    ds_read_b128 v[88:91], v5 offset:18432
    s_waitcnt lgkmcnt(3)
    v_mfma_f32_32x32x16_bf16 v[16:31], v[236:239], v[92:95], v[16:31]
    ds_read_b128 v[92:95], v5 offset:19456
    s_waitcnt lgkmcnt(3)
    v_mfma_f32_32x32x16_bf16 v[16:31], v[240:243], v[80:83], v[16:31]
    ds_read_b128 v[48:51], v14 offset:0
    ds_read_b128 v[80:83], v5 offset:20480
    s_waitcnt lgkmcnt(4)
    v_mfma_f32_32x32x16_bf16 v[16:31], v[244:247], v[84:87], v[16:31]
    ds_read_b128 v[52:55], v14 offset:16
    ds_read_b128 v[84:87], v5 offset:21504
    s_waitcnt lgkmcnt(5)
    v_mfma_f32_32x32x16_bf16 v[16:31], v[248:251], v[88:91], v[16:31]
    ds_read_b128 v[56:59], v14 offset:32
    ds_read_b128 v[88:91], v5 offset:22528
    s_waitcnt lgkmcnt(6)
    v_mfma_f32_32x32x16_bf16 v[16:31], v[252:255], v[92:95], v[16:31]
    ds_read_b128 v[60:63], v14 offset:48
    ds_read_b128 v[92:95], v5 offset:23552
    s_waitcnt lgkmcnt(6)
    v_mfma_f32_32x32x16_bf16 v[16:31], v[96:99], v[80:83], v[16:31]
    ds_read_b128 v[64:67], v14 offset:128
    ds_read_b128 v[80:83], v5 offset:24576
    s_waitcnt lgkmcnt(6)
    v_mfma_f32_32x32x16_bf16 v[16:31], v[100:103], v[84:87], v[16:31]
    ds_read_b128 v[68:71], v14 offset:144
    ds_read_b128 v[84:87], v5 offset:25600
    s_waitcnt lgkmcnt(6)
    v_mfma_f32_32x32x16_bf16 v[16:31], v[104:107], v[88:91], v[16:31]
    ds_read_b128 v[72:75], v14 offset:160
    ds_read_b128 v[88:91], v5 offset:26624
    s_waitcnt lgkmcnt(6)
    v_mfma_f32_32x32x16_bf16 v[16:31], v[108:111], v[92:95], v[16:31]
    ds_read_b128 v[76:79], v14 offset:176
    ds_read_b128 v[92:95], v5 offset:27648
    s_waitcnt lgkmcnt(6)
    v_mfma_f32_32x32x16_bf16 v[16:31], v[112:115], v[80:83], v[16:31]
    s_waitcnt lgkmcnt(4)
    v_mfma_f32_32x32x16_bf16 v[16:31], v[116:119], v[84:87], v[16:31]
    s_waitcnt lgkmcnt(2)
    v_mfma_f32_32x32x16_bf16 v[16:31], v[120:123], v[88:91], v[16:31]
    s_waitcnt lgkmcnt(0)
    v_mfma_f32_32x32x16_bf16 v[16:31], v[124:127], v[92:95], v[16:31]
    s_setprio 0
    s_barrier
    ds_read_b128 v[80:83], v5 offset:28672
    ds_read_b128 v[84:87], v5 offset:29696
    ds_read_b128 v[88:91], v5 offset:30720
    s_nop 3
    v_fma_f32 v48, v9, v48, v64
    v_fma_f32 v49, v9, v49, v65
    v_fma_f32 v50, v9, v50, v66
    v_fma_f32 v51, v9, v51, v67
    v_fma_f32 v52, v9, v52, v68
    v_fma_f32 v53, v9, v53, v69
    v_fma_f32 v54, v9, v54, v70
    v_fma_f32 v55, v9, v55, v71
    v_fma_f32 v56, v9, v56, v72
    v_fma_f32 v57, v9, v57, v73
    v_fma_f32 v58, v9, v58, v74
    v_fma_f32 v59, v9, v59, v75
    v_fma_f32 v60, v9, v60, v76
    v_fma_f32 v61, v9, v61, v77
    v_fma_f32 v62, v9, v62, v78
    v_fma_f32 v63, v9, v63, v79
    v_fma_f32 v16, v8, v16, v48
    v_fma_f32 v17, v8, v17, v49
    v_fma_f32 v18, v8, v18, v50
    v_fma_f32 v19, v8, v19, v51
    v_fma_f32 v20, v8, v20, v52
    v_fma_f32 v21, v8, v21, v53
    v_fma_f32 v22, v8, v22, v54
    v_fma_f32 v23, v8, v23, v55
    v_fma_f32 v24, v8, v24, v56
    v_fma_f32 v25, v8, v25, v57
    v_fma_f32 v26, v8, v26, v58
    v_fma_f32 v27, v8, v27, v59
    v_fma_f32 v28, v8, v28, v60
    v_fma_f32 v29, v8, v29, v61
    v_fma_f32 v30, v8, v30, v62
    v_fma_f32 v31, v8, v31, v63
    v_exp_f32 v48, v16
    v_exp_f32 v49, v17
    v_exp_f32 v50, v18
    v_exp_f32 v51, v19
    v_exp_f32 v52, v20
    v_exp_f32 v53, v21
    v_exp_f32 v54, v22
    v_exp_f32 v55, v23
    v_exp_f32 v56, v24
    v_exp_f32 v57, v25
    v_exp_f32 v58, v26
    v_exp_f32 v59, v27
    v_exp_f32 v60, v28
    v_exp_f32 v61, v29
    v_exp_f32 v62, v30
    v_exp_f32 v63, v31
    v_add_f32 v48, 1.0, v48
    v_add_f32 v49, 1.0, v49
    v_add_f32 v50, 1.0, v50
    v_add_f32 v51, 1.0, v51
    v_add_f32 v52, 1.0, v52
    v_add_f32 v53, 1.0, v53
    v_add_f32 v54, 1.0, v54
    v_add_f32 v55, 1.0, v55
    v_add_f32 v56, 1.0, v56
    v_add_f32 v57, 1.0, v57
    v_add_f32 v58, 1.0, v58
    v_add_f32 v59, 1.0, v59
    v_add_f32 v60, 1.0, v60
    v_add_f32 v61, 1.0, v61
    v_add_f32 v62, 1.0, v62
    v_add_f32 v63, 1.0, v63
    v_fma_f32 v48, v48, v48, 1.0
    v_fma_f32 v49, v49, v49, 1.0
    v_fma_f32 v50, v50, v50, 1.0
    v_fma_f32 v51, v51, v51, 1.0
    v_fma_f32 v52, v52, v52, 1.0
    v_fma_f32 v53, v53, v53, 1.0
    v_fma_f32 v54, v54, v54, 1.0
    v_fma_f32 v55, v55, v55, 1.0
    v_fma_f32 v56, v56, v56, 1.0
    v_fma_f32 v57, v57, v57, 1.0
    v_fma_f32 v58, v58, v58, 1.0
    v_fma_f32 v59, v59, v59, 1.0
    v_fma_f32 v60, v60, v60, 1.0
    v_fma_f32 v61, v61, v61, 1.0
    v_fma_f32 v62, v62, v62, 1.0
    v_fma_f32 v63, v63, v63, 1.0
    v_rcp_f32 v48, v48
    v_rcp_f32 v49, v49
    v_rcp_f32 v50, v50
    v_rcp_f32 v51, v51
    v_rcp_f32 v52, v52
    v_rcp_f32 v53, v53
    v_rcp_f32 v54, v54
    v_rcp_f32 v55, v55
    v_rcp_f32 v56, v56
    v_rcp_f32 v57, v57
    v_rcp_f32 v58, v58
    v_rcp_f32 v59, v59
    v_rcp_f32 v60, v60
    v_rcp_f32 v61, v61
    v_rcp_f32 v62, v62
    v_rcp_f32 v63, v63
    v_fma_f32 v48, v48, v12, v13
    v_fma_f32 v49, v49, v12, v13
    v_fma_f32 v50, v50, v12, v13
    v_fma_f32 v51, v51, v12, v13
    v_fma_f32 v52, v52, v12, v13
    v_fma_f32 v53, v53, v12, v13
    v_fma_f32 v54, v54, v12, v13
    v_fma_f32 v55, v55, v12, v13
    v_fma_f32 v56, v56, v12, v13
    v_fma_f32 v57, v57, v12, v13
    v_fma_f32 v58, v58, v12, v13
    v_fma_f32 v59, v59, v12, v13
    v_fma_f32 v60, v60, v12, v13
    v_fma_f32 v61, v61, v12, v13
    v_fma_f32 v62, v62, v12, v13
    v_fma_f32 v63, v63, v12, v13
    v_mul_f32 v16, v16, v48
    v_mul_f32 v17, v17, v49
    v_mul_f32 v18, v18, v50
    v_mul_f32 v19, v19, v51
    v_mul_f32 v20, v20, v52
    v_mul_f32 v21, v21, v53
    v_mul_f32 v22, v22, v54
    v_mul_f32 v23, v23, v55
    v_mul_f32 v24, v24, v56
    v_mul_f32 v25, v25, v57
    v_mul_f32 v26, v26, v58
    v_mul_f32 v27, v27, v59
    v_mul_f32 v28, v28, v60
    v_mul_f32 v29, v29, v61
    v_mul_f32 v30, v30, v62
    v_mul_f32 v31, v31, v63
    v_cvt_pk_bf16_f32 v64, v16, v17
    v_cvt_pk_bf16_f32 v65, v18, v19
    v_cvt_pk_bf16_f32 v66, v20, v21
    v_cvt_pk_bf16_f32 v67, v22, v23
    v_cvt_pk_bf16_f32 v68, v24, v25
    v_cvt_pk_bf16_f32 v69, v26, v27
    v_cvt_pk_bf16_f32 v70, v28, v29
    v_cvt_pk_bf16_f32 v71, v30, v31
    s_cmp_eq_u32 s48, 0
    s_cbranch_scc1 hs_66
    buffer_store_dwordx4 v[64:67], v5, s[4:7], s38 offen
    buffer_store_dwordx4 v[68:71], v5, s[4:7], s38 offen offset:1024
    s_branch hs_67
hs_66:
    buffer_store_dwordx4 v[64:67], v5, s[4:7], s38 offen sc1
    buffer_store_dwordx4 v[68:71], v5, s[4:7], s38 offen offset:1024 sc1
hs_67:
    s_setprio 1
    ds_read_b128 v[92:95], v5 offset:31744
    s_waitcnt lgkmcnt(3)
    v_mfma_f32_32x32x16_bf16 v[32:47], v[176:179], v[80:83], 0
    s_add_u32 m0, s33, 18432
    s_add_u32 s36, s30, 15360
    buffer_load_dwordx4 v5, s[4:7], s36 offen lds
    ds_read_b128 v[80:83], v5 offset:32768
    s_waitcnt lgkmcnt(3)
    v_mfma_f32_32x32x16_bf16 v[32:47], v[180:183], v[84:87], v[32:47]
    s_add_u32 m0, s33, 19456
    s_add_u32 s36, s31, 15360
    buffer_load_dwordx4 v5, s[4:7], s36 offen lds
    ds_read_b128 v[84:87], v5 offset:33792
    s_waitcnt lgkmcnt(3)
    v_mfma_f32_32x32x16_bf16 v[32:47], v[184:187], v[88:91], v[32:47]
    s_add_u32 m0, s33, 20480
    s_add_u32 s36, s30, 16384
    buffer_load_dwordx4 v5, s[4:7], s36 offen lds
    ds_read_b128 v[88:91], v5 offset:34816
    s_waitcnt lgkmcnt(3)
    v_mfma_f32_32x32x16_bf16 v[32:47], v[188:191], v[92:95], v[32:47]
    s_add_u32 m0, s33, 21504
    s_add_u32 s36, s31, 16384
    buffer_load_dwordx4 v5, s[4:7], s36 offen lds
    ds_read_b128 v[92:95], v5 offset:35840
    s_waitcnt lgkmcnt(3)
    v_mfma_f32_32x32x16_bf16 v[32:47], v[192:195], v[80:83], v[32:47]
    s_add_u32 m0, s33, 22528
    s_add_u32 s36, s30, 17408
    buffer_load_dwordx4 v5, s[4:7], s36 offen lds
    ds_read_b128 v[80:83], v5 offset:36864
    s_waitcnt lgkmcnt(3)
    v_mfma_f32_32x32x16_bf16 v[32:47], v[196:199], v[84:87], v[32:47]
    s_add_u32 m0, s33, 23552
    s_add_u32 s36, s31, 17408
    buffer_load_dwordx4 v5, s[4:7], s36 offen lds
    ds_read_b128 v[84:87], v5 offset:37888
    s_waitcnt lgkmcnt(3)
    v_mfma_f32_32x32x16_bf16 v[32:47], v[200:203], v[88:91], v[32:47]
    ds_read_b128 v[88:91], v5 offset:38912
    s_waitcnt lgkmcnt(3)
    v_mfma_f32_32x32x16_bf16 v[32:47], v[204:207], v[92:95], v[32:47]
    ds_read_b128 v[92:95], v5 offset:39936
    s_waitcnt lgkmcnt(3)
    v_mfma_f32_32x32x16_bf16 v[32:47], v[208:211], v[80:83], v[32:47]
    ds_read_b128 v[80:83], v5 offset:40960
    s_waitcnt lgkmcnt(3)
    v_mfma_f32_32x32x16_bf16 v[32:47], v[212:215], v[84:87], v[32:47]
    s_add_u32 s36, s30, 16384
    buffer_load_dwordx4 v[176:179], v5, s[4:7], s36 offen offset:2048
    ds_read_b128 v[84:87], v5 offset:41984
    s_waitcnt lgkmcnt(3)
    v_mfma_f32_32x32x16_bf16 v[32:47], v[216:219], v[88:91], v[32:47]
    ds_read_b128 v[88:91], v5 offset:43008
    s_waitcnt lgkmcnt(3)
    v_mfma_f32_32x32x16_bf16 v[32:47], v[220:223], v[92:95], v[32:47]
    s_add_u32 s36, s31, 16384
    buffer_load_dwordx4 v[180:183], v5, s[4:7], s36 offen offset:2048
    ds_read_b128 v[92:95], v5 offset:44032
    s_waitcnt lgkmcnt(3)
    v_mfma_f32_32x32x16_bf16 v[32:47], v[224:227], v[80:83], v[32:47]
    ds_read_b128 v[80:83], v5 offset:45056
    s_waitcnt lgkmcnt(3)
    v_mfma_f32_32x32x16_bf16 v[32:47], v[228:231], v[84:87], v[32:47]
    s_add_u32 s36, s30, 16384
    buffer_load_dwordx4 v[184:187], v5, s[4:7], s36 offen offset:3072
    ds_read_b128 v[84:87], v5 offset:46080
    s_waitcnt lgkmcnt(3)
    v_mfma_f32_32x32x16_bf16 v[32:47], v[232:235], v[88:91], v[32:47]
    ds_read_b128 v[88:91], v5 offset:47104
    s_waitcnt lgkmcnt(3)
    v_mfma_f32_32x32x16_bf16 v[32:47], v[236:239], v[92:95], v[32:47]
    s_add_u32 s36, s31, 16384
    buffer_load_dwordx4 v[188:191], v5, s[4:7], s36 offen offset:3072
    ds_read_b128 v[92:95], v5 offset:48128
    s_waitcnt lgkmcnt(3)
    v_mfma_f32_32x32x16_bf16 v[32:47], v[240:243], v[80:83], v[32:47]
    ds_read_b128 v[48:51], v14 offset:0
    ds_read_b128 v[80:83], v5 offset:49152
    s_waitcnt lgkmcnt(4)
    v_mfma_f32_32x32x16_bf16 v[32:47], v[244:247], v[84:87], v[32:47]
    ds_read_b128 v[52:55], v14 offset:16
    s_add_u32 s36, s30, 20480
    buffer_load_dwordx4 v[192:195], v5, s[4:7], s36 offen offset:0
    ds_read_b128 v[84:87], v5 offset:50176
    s_waitcnt lgkmcnt(5)
    v_mfma_f32_32x32x16_bf16 v[32:47], v[248:251], v[88:91], v[32:47]
    ds_read_b128 v[56:59], v14 offset:32
    ds_read_b128 v[88:91], v5 offset:51200
    s_waitcnt lgkmcnt(6)
    v_mfma_f32_32x32x16_bf16 v[32:47], v[252:255], v[92:95], v[32:47]
    ds_read_b128 v[60:63], v14 offset:48
    s_add_u32 s36, s31, 20480
    buffer_load_dwordx4 v[196:199], v5, s[4:7], s36 offen offset:0
    ds_read_b128 v[92:95], v5 offset:52224
    s_waitcnt lgkmcnt(6)
    v_mfma_f32_32x32x16_bf16 v[32:47], v[96:99], v[80:83], v[32:47]
    ds_read_b128 v[64:67], v14 offset:128
    ds_read_b128 v[80:83], v5 offset:53248
    s_waitcnt lgkmcnt(6)
    v_mfma_f32_32x32x16_bf16 v[32:47], v[100:103], v[84:87], v[32:47]
    ds_read_b128 v[68:71], v14 offset:144
    s_add_u32 s36, s30, 20480
    buffer_load_dwordx4 v[200:203], v5, s[4:7], s36 offen offset:1024
    ds_read_b128 v[84:87], v5 offset:54272
    s_waitcnt lgkmcnt(6)
    v_mfma_f32_32x32x16_bf16 v[32:47], v[104:107], v[88:91], v[32:47]
    ds_read_b128 v[72:75], v14 offset:160
    ds_read_b128 v[88:91], v5 offset:55296
    s_waitcnt lgkmcnt(6)
    v_mfma_f32_32x32x16_bf16 v[32:47], v[108:111], v[92:95], v[32:47]
    ds_read_b128 v[76:79], v14 offset:176
    s_add_u32 s36, s31, 20480
    buffer_load_dwordx4 v[204:207], v5, s[4:7], s36 offen offset:1024
    ds_read_b128 v[92:95], v5 offset:56320
    s_waitcnt lgkmcnt(6)
    v_mfma_f32_32x32x16_bf16 v[32:47], v[112:115], v[80:83], v[32:47]
    s_waitcnt lgkmcnt(4)
    v_mfma_f32_32x32x16_bf16 v[32:47], v[116:119], v[84:87], v[32:47]
    s_waitcnt lgkmcnt(2)
    v_mfma_f32_32x32x16_bf16 v[32:47], v[120:123], v[88:91], v[32:47]
    s_waitcnt lgkmcnt(0)
    v_mfma_f32_32x32x16_bf16 v[32:47], v[124:127], v[92:95], v[32:47]
    s_setprio 0
    s_nop 7
    v_fma_f32 v48, v11, v48, v64
    v_fma_f32 v49, v11, v49, v65
    v_fma_f32 v50, v11, v50, v66
    v_fma_f32 v51, v11, v51, v67
    v_fma_f32 v52, v11, v52, v68
    v_fma_f32 v53, v11, v53, v69
    v_fma_f32 v54, v11, v54, v70
    v_fma_f32 v55, v11, v55, v71
    v_fma_f32 v56, v11, v56, v72
    v_fma_f32 v57, v11, v57, v73
    v_fma_f32 v58, v11, v58, v74
    v_fma_f32 v59, v11, v59, v75
    v_fma_f32 v60, v11, v60, v76
    v_fma_f32 v61, v11, v61, v77
    v_fma_f32 v62, v11, v62, v78
    v_fma_f32 v63, v11, v63, v79
    v_fma_f32 v32, v10, v32, v48
    v_fma_f32 v33, v10, v33, v49
    v_fma_f32 v34, v10, v34, v50
    v_fma_f32 v35, v10, v35, v51
    v_fma_f32 v36, v10, v36, v52
    v_fma_f32 v37, v10, v37, v53
    v_fma_f32 v38, v10, v38, v54
    v_fma_f32 v39, v10, v39, v55
    v_fma_f32 v40, v10, v40, v56
    v_fma_f32 v41, v10, v41, v57
    v_fma_f32 v42, v10, v42, v58
    v_fma_f32 v43, v10, v43, v59
    v_fma_f32 v44, v10, v44, v60
    v_fma_f32 v45, v10, v45, v61
    v_fma_f32 v46, v10, v46, v62
    v_fma_f32 v47, v10, v47, v63
    v_exp_f32 v48, v32
    v_exp_f32 v49, v33
    v_exp_f32 v50, v34
    v_exp_f32 v51, v35
    v_exp_f32 v52, v36
    v_exp_f32 v53, v37
    v_exp_f32 v54, v38
    v_exp_f32 v55, v39
    v_exp_f32 v56, v40
    v_exp_f32 v57, v41
    v_exp_f32 v58, v42
    v_exp_f32 v59, v43
    v_exp_f32 v60, v44
    v_exp_f32 v61, v45
    v_exp_f32 v62, v46
    v_exp_f32 v63, v47
    v_add_f32 v48, 1.0, v48
    v_add_f32 v49, 1.0, v49
    v_add_f32 v50, 1.0, v50
    v_add_f32 v51, 1.0, v51
    v_add_f32 v52, 1.0, v52
    v_add_f32 v53, 1.0, v53
    v_add_f32 v54, 1.0, v54
    v_add_f32 v55, 1.0, v55
    v_add_f32 v56, 1.0, v56
    v_add_f32 v57, 1.0, v57
    v_add_f32 v58, 1.0, v58
    v_add_f32 v59, 1.0, v59
    v_add_f32 v60, 1.0, v60
    v_add_f32 v61, 1.0, v61
    v_add_f32 v62, 1.0, v62
    v_add_f32 v63, 1.0, v63
    v_fma_f32 v48, v48, v48, 1.0
    v_fma_f32 v49, v49, v49, 1.0
    v_fma_f32 v50, v50, v50, 1.0
    v_fma_f32 v51, v51, v51, 1.0
    v_fma_f32 v52, v52, v52, 1.0
    v_fma_f32 v53, v53, v53, 1.0
    v_fma_f32 v54, v54, v54, 1.0
    v_fma_f32 v55, v55, v55, 1.0
    v_fma_f32 v56, v56, v56, 1.0
    v_fma_f32 v57, v57, v57, 1.0
    v_fma_f32 v58, v58, v58, 1.0
    v_fma_f32 v59, v59, v59, 1.0
    v_fma_f32 v60, v60, v60, 1.0
    v_fma_f32 v61, v61, v61, 1.0
    v_fma_f32 v62, v62, v62, 1.0
    v_fma_f32 v63, v63, v63, 1.0
    v_rcp_f32 v48, v48
    v_rcp_f32 v49, v49
    v_rcp_f32 v50, v50
    v_rcp_f32 v51, v51
    v_rcp_f32 v52, v52
    v_rcp_f32 v53, v53
    v_rcp_f32 v54, v54
    v_rcp_f32 v55, v55
    v_rcp_f32 v56, v56
    v_rcp_f32 v57, v57
    v_rcp_f32 v58, v58
    v_rcp_f32 v59, v59
    v_rcp_f32 v60, v60
    v_rcp_f32 v61, v61
    v_rcp_f32 v62, v62
    v_rcp_f32 v63, v63
    v_fma_f32 v48, v48, v12, v13
    v_fma_f32 v49, v49, v12, v13
    v_fma_f32 v50, v50, v12, v13
    v_fma_f32 v51, v51, v12, v13
    v_fma_f32 v52, v52, v12, v13
    v_fma_f32 v53, v53, v12, v13
    v_fma_f32 v54, v54, v12, v13
    v_fma_f32 v55, v55, v12, v13
    v_fma_f32 v56, v56, v12, v13
    v_fma_f32 v57, v57, v12, v13
    v_fma_f32 v58, v58, v12, v13
    v_fma_f32 v59, v59, v12, v13
    v_fma_f32 v60, v60, v12, v13
    v_fma_f32 v61, v61, v12, v13
    v_fma_f32 v62, v62, v12, v13
    v_fma_f32 v63, v63, v12, v13
    v_mul_f32 v32, v32, v48
    v_mul_f32 v33, v33, v49
    v_mul_f32 v34, v34, v50
    v_mul_f32 v35, v35, v51
    v_mul_f32 v36, v36, v52
    v_mul_f32 v37, v37, v53
    v_mul_f32 v38, v38, v54
    v_mul_f32 v39, v39, v55
    v_mul_f32 v40, v40, v56
    v_mul_f32 v41, v41, v57
    v_mul_f32 v42, v42, v58
    v_mul_f32 v43, v43, v59
    v_mul_f32 v44, v44, v60
    v_mul_f32 v45, v45, v61
    v_mul_f32 v46, v46, v62
    v_mul_f32 v47, v47, v63
    v_cvt_pk_bf16_f32 v64, v32, v33
    v_cvt_pk_bf16_f32 v65, v34, v35
    v_cvt_pk_bf16_f32 v66, v36, v37
    v_cvt_pk_bf16_f32 v67, v38, v39
    v_cvt_pk_bf16_f32 v68, v40, v41
    v_cvt_pk_bf16_f32 v69, v42, v43
    v_cvt_pk_bf16_f32 v70, v44, v45
    v_cvt_pk_bf16_f32 v71, v46, v47
    s_cmp_eq_u32 s48, 0
    s_cbranch_scc1 hs_68
    buffer_store_dwordx4 v[64:67], v5, s[4:7], s39 offen
    buffer_store_dwordx4 v[68:71], v5, s[4:7], s39 offen offset:1024
    s_branch hs_69
hs_68:
    buffer_store_dwordx4 v[64:67], v5, s[4:7], s39 offen sc1
    buffer_store_dwordx4 v[68:71], v5, s[4:7], s39 offen offset:1024 sc1
hs_69:
    s_barrier
    s_add_u32 m0, s35, 0
    s_add_u32 s36, s30, 22528
    buffer_load_dwordx4 v5, s[4:7], s36 offen lds
    s_add_u32 m0, s35, 1024
    s_add_u32 s36, s31, 22528
    buffer_load_dwordx4 v5, s[4:7], s36 offen lds
    s_add_u32 m0, s35, 2048
    s_add_u32 s36, s30, 23552
    buffer_load_dwordx4 v5, s[4:7], s36 offen lds
    s_add_u32 m0, s35, 3072
    s_add_u32 s36, s31, 23552
    buffer_load_dwordx4 v5, s[4:7], s36 offen lds
    s_add_u32 m0, s35, 4096
    s_add_u32 s36, s30, 24576
    buffer_load_dwordx4 v5, s[4:7], s36 offen lds
    s_add_u32 m0, s35, 5120
    s_add_u32 s36, s31, 24576
    buffer_load_dwordx4 v5, s[4:7], s36 offen lds
    s_add_u32 m0, s35, 6144
    s_add_u32 s36, s30, 25600
    buffer_load_dwordx4 v5, s[4:7], s36 offen lds
    s_add_u32 m0, s35, 7168
    s_add_u32 s36, s31, 25600
    buffer_load_dwordx4 v5, s[4:7], s36 offen lds
    s_add_u32 m0, s35, 8192
    s_add_u32 s36, s30, 26624
    buffer_load_dwordx4 v5, s[4:7], s36 offen lds
    s_add_u32 m0, s35, 9216
    s_add_u32 s36, s31, 26624
    buffer_load_dwordx4 v5, s[4:7], s36 offen lds
    s_add_u32 m0, s35, 10240
    s_add_u32 s36, s30, 27648
    buffer_load_dwordx4 v5, s[4:7], s36 offen lds
    s_add_u32 m0, s35, 11264
    s_add_u32 s36, s31, 27648
    buffer_load_dwordx4 v5, s[4:7], s36 offen lds
    s_branch fj_65
fb_64:
    s_add_u32 m0, s33, 0
    s_add_u32 s36, s30, 6144
    buffer_load_dwordx4 v5, s[4:7], s36 offen lds
    s_add_u32 m0, s33, 1024
    s_add_u32 s36, s31, 6144
    buffer_load_dwordx4 v5, s[4:7], s36 offen lds
    s_add_u32 m0, s33, 2048
    s_add_u32 s36, s30, 7168
    buffer_load_dwordx4 v5, s[4:7], s36 offen lds
    s_add_u32 m0, s33, 3072
    s_add_u32 s36, s31, 7168
    buffer_load_dwordx4 v5, s[4:7], s36 offen lds
    s_add_u32 m0, s33, 4096
    s_add_u32 s36, s30, 8192
    buffer_load_dwordx4 v5, s[4:7], s36 offen lds
    s_add_u32 m0, s33, 5120
    s_add_u32 s36, s31, 8192
    buffer_load_dwordx4 v5, s[4:7], s36 offen lds
    s_add_u32 m0, s33, 6144
    s_add_u32 s36, s30, 9216
    buffer_load_dwordx4 v5, s[4:7], s36 offen lds
    s_add_u32 m0, s33, 7168
    s_add_u32 s36, s31, 9216
    buffer_load_dwordx4 v5, s[4:7], s36 offen lds
    s_add_u32 m0, s33, 8192
    s_add_u32 s36, s30, 10240
    buffer_load_dwordx4 v5, s[4:7], s36 offen lds
    s_add_u32 m0, s33, 9216
    s_add_u32 s36, s31, 10240
    buffer_load_dwordx4 v5, s[4:7], s36 offen lds
    s_add_u32 m0, s33, 10240
    s_add_u32 s36, s30, 11264
    buffer_load_dwordx4 v5, s[4:7], s36 offen lds
    s_add_u32 m0, s33, 11264
    s_add_u32 s36, s31, 11264
    buffer_load_dwordx4 v5, s[4:7], s36 offen lds
    ds_read_b128 v[80:83], v5 offset:0
    ds_read_b128 v[84:87], v5 offset:1024
    ds_read_b128 v[88:91], v5 offset:2048
    s_barrier
    s_setprio 1
    ds_read_b128 v[92:95], v5 offset:3072
    s_waitcnt lgkmcnt(3)
    v_mfma_f32_32x32x16_bf16 v[16:31], v[176:179], v[80:83], 0
    ds_read_b128 v[80:83], v5 offset:4096
    s_waitcnt lgkmcnt(3)
    v_mfma_f32_32x32x16_bf16 v[16:31], v[180:183], v[84:87], v[16:31]
    ds_read_b128 v[84:87], v5 offset:5120
    s_waitcnt lgkmcnt(3)
    v_mfma_f32_32x32x16_bf16 v[16:31], v[184:187], v[88:91], v[16:31]
    s_add_u32 m0, s33, 12288
    s_add_u32 s36, s30, 12288
    buffer_load_dwordx4 v5, s[4:7], s36 offen lds
    ds_read_b128 v[88:91], v5 offset:6144
    s_waitcnt lgkmcnt(3)
    v_mfma_f32_32x32x16_bf16 v[16:31], v[188:191], v[92:95], v[16:31]
    ds_read_b128 v[92:95], v5 offset:7168
    s_waitcnt lgkmcnt(3)
    v_mfma_f32_32x32x16_bf16 v[16:31], v[192:195], v[80:83], v[16:31]
    ds_read_b128 v[80:83], v5 offset:8192
    s_waitcnt lgkmcnt(3)
    v_mfma_f32_32x32x16_bf16 v[16:31], v[196:199], v[84:87], v[16:31]
    ds_read_b128 v[84:87], v5 offset:9216
    s_waitcnt lgkmcnt(3)
    v_mfma_f32_32x32x16_bf16 v[16:31], v[200:203], v[88:91], v[16:31]
    s_add_u32 m0, s33, 13312
    s_add_u32 s36, s31, 12288
    buffer_load_dwordx4 v5, s[4:7], s36 offen lds
    ds_read_b128 v[88:91], v5 offset:10240
    s_waitcnt lgkmcnt(3)
    v_mfma_f32_32x32x16_bf16 v[16:31], v[204:207], v[92:95], v[16:31]
    ds_read_b128 v[92:95], v5 offset:11264
    s_waitcnt lgkmcnt(3)
    v_mfma_f32_32x32x16_bf16 v[16:31], v[208:211], v[80:83], v[16:31]
    ds_read_b128 v[80:83], v5 offset:12288
    s_waitcnt lgkmcnt(3)
    v_mfma_f32_32x32x16_bf16 v[16:31], v[212:215], v[84:87], v[16:31]
    ds_read_b128 v[84:87], v5 offset:13312
    s_waitcnt lgkmcnt(3)
    v_mfma_f32_32x32x16_bf16 v[16:31], v[216:219], v[88:91], v[16:31]
    v_lshlrev_b32 v15, 3, v4
    v_add_u32 v15, 59392, v15
    ds_read_b64 v[8:9], v15
    ds_read_b64 v[10:11], v15 offset:256
    s_add_u32 m0, s33, 14336
    s_add_u32 s36, s30, 13312
    buffer_load_dwordx4 v5, s[4:7], s36 offen lds
    ds_read_b128 v[88:91], v5 offset:14336
    s_waitcnt lgkmcnt(5)
    v_mfma_f32_32x32x16_bf16 v[16:31], v[220:223], v[92:95], v[16:31]
    ds_read_b128 v[92:95], v5 offset:15360
    s_waitcnt lgkmcnt(5)
    v_mfma_f32_32x32x16_bf16 v[16:31], v[224:227], v[80:83], v[16:31]
    ds_read_b128 v[80:83], v5 offset:16384
    s_waitcnt lgkmcnt(5)
    v_mfma_f32_32x32x16_bf16 v[16:31], v[228:231], v[84:87], v[16:31]
    ds_read_b128 v[84:87], v5 offset:17408
    s_waitcnt lgkmcnt(3)
    v_mfma_f32_32x32x16_bf16 v[16:31], v[232:235], v[88:91], v[16:31]
    s_add_u32 m0, s33, 15360
    s_add_u32 s36, s31, 13312
    buffer_load_dwordx4 v5, s[4:7], s36 offen lds
    ds_read_b128 v[88:91], v5 offset:18432
    s_waitcnt lgkmcnt(3)
    v_mfma_f32_32x32x16_bf16 v[16:31], v[236:239], v[92:95], v[16:31]
    ds_read_b128 v[92:95], v5 offset:19456
    s_waitcnt lgkmcnt(3)
    v_mfma_f32_32x32x16_bf16 v[16:31], v[240:243], v[80:83], v[16:31]
    ds_read_b128 v[48:51], v14 offset:0
    ds_read_b128 v[80:83], v5 offset:20480
    s_waitcnt lgkmcnt(4)
    v_mfma_f32_32x32x16_bf16 v[16:31], v[244:247], v[84:87], v[16:31]
    ds_read_b128 v[52:55], v14 offset:16
    ds_read_b128 v[84:87], v5 offset:21504
    s_waitcnt lgkmcnt(5)
    v_mfma_f32_32x32x16_bf16 v[16:31], v[248:251], v[88:91], v[16:31]
    ds_read_b128 v[56:59], v14 offset:32
    s_add_u32 m0, s33, 16384
    s_add_u32 s36, s30, 14336
    buffer_load_dwordx4 v5, s[4:7], s36 offen lds
    ds_read_b128 v[88:91], v5 offset:22528
    s_waitcnt lgkmcnt(6)
    v_mfma_f32_32x32x16_bf16 v[16:31], v[252:255], v[92:95], v[16:31]
    ds_read_b128 v[60:63], v14 offset:48
    ds_read_b128 v[92:95], v5 offset:23552
    s_waitcnt lgkmcnt(6)
    v_mfma_f32_32x32x16_bf16 v[16:31], v[96:99], v[80:83], v[16:31]
    ds_read_b128 v[64:67], v14 offset:128
    ds_read_b128 v[80:83], v5 offset:24576
    s_waitcnt lgkmcnt(6)
    v_mfma_f32_32x32x16_bf16 v[16:31], v[100:103], v[84:87], v[16:31]
    ds_read_b128 v[68:71], v14 offset:144
    ds_read_b128 v[84:87], v5 offset:25600
    s_waitcnt lgkmcnt(6)
    v_mfma_f32_32x32x16_bf16 v[16:31], v[104:107], v[88:91], v[16:31]
    ds_read_b128 v[72:75], v14 offset:160
    s_add_u32 m0, s33, 17408
    s_add_u32 s36, s31, 14336
    buffer_load_dwordx4 v5, s[4:7], s36 offen lds
    ds_read_b128 v[88:91], v5 offset:26624
    s_waitcnt lgkmcnt(6)
    v_mfma_f32_32x32x16_bf16 v[16:31], v[108:111], v[92:95], v[16:31]
    ds_read_b128 v[76:79], v14 offset:176
    ds_read_b128 v[92:95], v5 offset:27648
    s_waitcnt lgkmcnt(6)
    v_mfma_f32_32x32x16_bf16 v[16:31], v[112:115], v[80:83], v[16:31]
    s_waitcnt lgkmcnt(4)
    v_mfma_f32_32x32x16_bf16 v[16:31], v[116:119], v[84:87], v[16:31]
    s_waitcnt lgkmcnt(2)
    v_mfma_f32_32x32x16_bf16 v[16:31], v[120:123], v[88:91], v[16:31]
    s_waitcnt lgkmcnt(0)
    v_mfma_f32_32x32x16_bf16 v[16:31], v[124:127], v[92:95], v[16:31]
    s_setprio 0
    ds_read_b128 v[80:83], v5 offset:28672
    ds_read_b128 v[84:87], v5 offset:29696
    ds_read_b128 v[88:91], v5 offset:30720
    s_nop 3
    v_fma_f32 v48, v9, v48, v64
    v_fma_f32 v49, v9, v49, v65
    v_fma_f32 v50, v9, v50, v66
    v_fma_f32 v51, v9, v51, v67
    v_fma_f32 v52, v9, v52, v68
    v_fma_f32 v53, v9, v53, v69
    v_fma_f32 v54, v9, v54, v70
    v_fma_f32 v55, v9, v55, v71
    v_fma_f32 v56, v9, v56, v72
    v_fma_f32 v57, v9, v57, v73
    v_fma_f32 v58, v9, v58, v74
    v_fma_f32 v59, v9, v59, v75
    v_fma_f32 v60, v9, v60, v76
    v_fma_f32 v61, v9, v61, v77
    v_fma_f32 v62, v9, v62, v78
    v_fma_f32 v63, v9, v63, v79
    v_fma_f32 v16, v8, v16, v48
    v_fma_f32 v17, v8, v17, v49
    v_fma_f32 v18, v8, v18, v50
    v_fma_f32 v19, v8, v19, v51
    v_fma_f32 v20, v8, v20, v52
    v_fma_f32 v21, v8, v21, v53
    v_fma_f32 v22, v8, v22, v54
    v_fma_f32 v23, v8, v23, v55
    v_fma_f32 v24, v8, v24, v56
    v_fma_f32 v25, v8, v25, v57
    v_fma_f32 v26, v8, v26, v58
    v_fma_f32 v27, v8, v27, v59
    v_fma_f32 v28, v8, v28, v60
    v_fma_f32 v29, v8, v29, v61
    v_fma_f32 v30, v8, v30, v62
    v_fma_f32 v31, v8, v31, v63
    v_exp_f32 v48, v16
    v_exp_f32 v49, v17
    v_exp_f32 v50, v18
    v_exp_f32 v51, v19
    v_exp_f32 v52, v20
    v_exp_f32 v53, v21
    v_exp_f32 v54, v22
    v_exp_f32 v55, v23
    v_exp_f32 v56, v24
    v_exp_f32 v57, v25
    v_exp_f32 v58, v26
    v_exp_f32 v59, v27
    v_exp_f32 v60, v28
    v_exp_f32 v61, v29
    v_exp_f32 v62, v30
    v_exp_f32 v63, v31
    v_add_f32 v48, 1.0, v48
    v_add_f32 v49, 1.0, v49
    v_add_f32 v50, 1.0, v50
    v_add_f32 v51, 1.0, v51
    v_add_f32 v52, 1.0, v52
    v_add_f32 v53, 1.0, v53
    v_add_f32 v54, 1.0, v54
    v_add_f32 v55, 1.0, v55
    v_add_f32 v56, 1.0, v56
    v_add_f32 v57, 1.0, v57
    v_add_f32 v58, 1.0, v58
    v_add_f32 v59, 1.0, v59
    v_add_f32 v60, 1.0, v60
    v_add_f32 v61, 1.0, v61
    v_add_f32 v62, 1.0, v62
    v_add_f32 v63, 1.0, v63
    v_fma_f32 v48, v48, v48, 1.0
    v_fma_f32 v49, v49, v49, 1.0
    v_fma_f32 v50, v50, v50, 1.0
    v_fma_f32 v51, v51, v51, 1.0
    v_fma_f32 v52, v52, v52, 1.0
    v_fma_f32 v53, v53, v53, 1.0
    v_fma_f32 v54, v54, v54, 1.0
    v_fma_f32 v55, v55, v55, 1.0
    v_fma_f32 v56, v56, v56, 1.0
    v_fma_f32 v57, v57, v57, 1.0
    v_fma_f32 v58, v58, v58, 1.0
    v_fma_f32 v59, v59, v59, 1.0
    v_fma_f32 v60, v60, v60, 1.0
    v_fma_f32 v61, v61, v61, 1.0
    v_fma_f32 v62, v62, v62, 1.0
    v_fma_f32 v63, v63, v63, 1.0
    v_rcp_f32 v48, v48
    v_rcp_f32 v49, v49
    v_rcp_f32 v50, v50
    v_rcp_f32 v51, v51
    v_rcp_f32 v52, v52
    v_rcp_f32 v53, v53
    v_rcp_f32 v54, v54
    v_rcp_f32 v55, v55
    v_rcp_f32 v56, v56
    v_rcp_f32 v57, v57
    v_rcp_f32 v58, v58
    v_rcp_f32 v59, v59
    v_rcp_f32 v60, v60
    v_rcp_f32 v61, v61
    v_rcp_f32 v62, v62
    v_rcp_f32 v63, v63
    v_fma_f32 v48, v48, v12, v13
    v_fma_f32 v49, v49, v12, v13
    v_fma_f32 v50, v50, v12, v13
    v_fma_f32 v51, v51, v12, v13
    v_fma_f32 v52, v52, v12, v13
    v_fma_f32 v53, v53, v12, v13
    v_fma_f32 v54, v54, v12, v13
    v_fma_f32 v55, v55, v12, v13
    v_fma_f32 v56, v56, v12, v13
    v_fma_f32 v57, v57, v12, v13
    v_fma_f32 v58, v58, v12, v13
    v_fma_f32 v59, v59, v12, v13
    v_fma_f32 v60, v60, v12, v13
    v_fma_f32 v61, v61, v12, v13
    v_fma_f32 v62, v62, v12, v13
    v_fma_f32 v63, v63, v12, v13
    v_mul_f32 v16, v16, v48
    v_mul_f32 v17, v17, v49
    v_mul_f32 v18, v18, v50
    v_mul_f32 v19, v19, v51
    v_mul_f32 v20, v20, v52
    v_mul_f32 v21, v21, v53
    v_mul_f32 v22, v22, v54
    v_mul_f32 v23, v23, v55
    v_mul_f32 v24, v24, v56
    v_mul_f32 v25, v25, v57
    v_mul_f32 v26, v26, v58
    v_mul_f32 v27, v27, v59
    v_mul_f32 v28, v28, v60
    v_mul_f32 v29, v29, v61
    v_mul_f32 v30, v30, v62
    v_mul_f32 v31, v31, v63
    v_cvt_pk_bf16_f32 v64, v16, v17
    v_cvt_pk_bf16_f32 v65, v18, v19
    v_cvt_pk_bf16_f32 v66, v20, v21
    v_cvt_pk_bf16_f32 v67, v22, v23
    v_cvt_pk_bf16_f32 v68, v24, v25
    v_cvt_pk_bf16_f32 v69, v26, v27
    v_cvt_pk_bf16_f32 v70, v28, v29
    v_cvt_pk_bf16_f32 v71, v30, v31
    s_cmp_eq_u32 s48, 0
    s_cbranch_scc1 hs_70
    buffer_store_dwordx4 v[64:67], v5, s[4:7], s38 offen
    buffer_store_dwordx4 v[68:71], v5, s[4:7], s38 offen offset:1024
    s_branch hs_71
hs_70:
    buffer_store_dwordx4 v[64:67], v5, s[4:7], s38 offen sc1
    buffer_store_dwordx4 v[68:71], v5, s[4:7], s38 offen offset:1024 sc1
hs_71:
    s_setprio 1
    ds_read_b128 v[92:95], v5 offset:31744
    s_waitcnt lgkmcnt(3)
    v_mfma_f32_32x32x16_bf16 v[32:47], v[176:179], v[80:83], 0
    ds_read_b128 v[80:83], v5 offset:32768
    s_waitcnt lgkmcnt(3)
    v_mfma_f32_32x32x16_bf16 v[32:47], v[180:183], v[84:87], v[32:47]
    ds_read_b128 v[84:87], v5 offset:33792
    s_waitcnt lgkmcnt(3)
    v_mfma_f32_32x32x16_bf16 v[32:47], v[184:187], v[88:91], v[32:47]
    ds_read_b128 v[88:91], v5 offset:34816
    s_waitcnt lgkmcnt(3)
    v_mfma_f32_32x32x16_bf16 v[32:47], v[188:191], v[92:95], v[32:47]
    ds_read_b128 v[92:95], v5 offset:35840
    s_waitcnt lgkmcnt(3)
    v_mfma_f32_32x32x16_bf16 v[32:47], v[192:195], v[80:83], v[32:47]
    ds_read_b128 v[80:83], v5 offset:36864
    s_waitcnt lgkmcnt(3)
    v_mfma_f32_32x32x16_bf16 v[32:47], v[196:199], v[84:87], v[32:47]
    ds_read_b128 v[84:87], v5 offset:37888
    s_waitcnt lgkmcnt(3)
    v_mfma_f32_32x32x16_bf16 v[32:47], v[200:203], v[88:91], v[32:47]
    ds_read_b128 v[88:91], v5 offset:38912
    s_waitcnt lgkmcnt(3)
    v_mfma_f32_32x32x16_bf16 v[32:47], v[204:207], v[92:95], v[32:47]
    ds_read_b128 v[92:95], v5 offset:39936
    s_waitcnt lgkmcnt(3)
    v_mfma_f32_32x32x16_bf16 v[32:47], v[208:211], v[80:83], v[32:47]
    ds_read_b128 v[80:83], v5 offset:40960
    s_waitcnt lgkmcnt(3)
    v_mfma_f32_32x32x16_bf16 v[32:47], v[212:215], v[84:87], v[32:47]
    s_add_u32 s36, s30, 16384
    buffer_load_dwordx4 v[176:179], v5, s[4:7], s36 offen offset:2048
    ds_read_b128 v[84:87], v5 offset:41984
    s_waitcnt lgkmcnt(3)
    v_mfma_f32_32x32x16_bf16 v[32:47], v[216:219], v[88:91], v[32:47]
    ds_read_b128 v[88:91], v5 offset:43008
    s_waitcnt lgkmcnt(3)
    v_mfma_f32_32x32x16_bf16 v[32:47], v[220:223], v[92:95], v[32:47]
    s_add_u32 s36, s31, 16384
    buffer_load_dwordx4 v[180:183], v5, s[4:7], s36 offen offset:2048
    ds_read_b128 v[92:95], v5 offset:44032
    s_waitcnt lgkmcnt(3)
    v_mfma_f32_32x32x16_bf16 v[32:47], v[224:227], v[80:83], v[32:47]
    ds_read_b128 v[80:83], v5 offset:45056
    s_waitcnt lgkmcnt(3)
    v_mfma_f32_32x32x16_bf16 v[32:47], v[228:231], v[84:87], v[32:47]
    s_add_u32 s36, s30, 16384
    buffer_load_dwordx4 v[184:187], v5, s[4:7], s36 offen offset:3072
    ds_read_b128 v[84:87], v5 offset:46080
    s_waitcnt lgkmcnt(3)
    v_mfma_f32_32x32x16_bf16 v[32:47], v[232:235], v[88:91], v[32:47]
    ds_read_b128 v[88:91], v5 offset:47104
    s_waitcnt lgkmcnt(3)
    v_mfma_f32_32x32x16_bf16 v[32:47], v[236:239], v[92:95], v[32:47]
    s_add_u32 s36, s31, 16384
    buffer_load_dwordx4 v[188:191], v5, s[4:7], s36 offen offset:3072
    ds_read_b128 v[92:95], v5 offset:48128
    s_waitcnt lgkmcnt(3)
    v_mfma_f32_32x32x16_bf16 v[32:47], v[240:243], v[80:83], v[32:47]
    ds_read_b128 v[48:51], v14 offset:0
    ds_read_b128 v[80:83], v5 offset:49152
    s_waitcnt lgkmcnt(4)
    v_mfma_f32_32x32x16_bf16 v[32:47], v[244:247], v[84:87], v[32:47]
    ds_read_b128 v[52:55], v14 offset:16
    s_add_u32 s36, s30, 20480
    buffer_load_dwordx4 v[192:195], v5, s[4:7], s36 offen offset:0
    ds_read_b128 v[84:87], v5 offset:50176
    s_waitcnt lgkmcnt(5)
    v_mfma_f32_32x32x16_bf16 v[32:47], v[248:251], v[88:91], v[32:47]
    ds_read_b128 v[56:59], v14 offset:32
    ds_read_b128 v[88:91], v5 offset:51200
    s_waitcnt lgkmcnt(6)
    v_mfma_f32_32x32x16_bf16 v[32:47], v[252:255], v[92:95], v[32:47]
    ds_read_b128 v[60:63], v14 offset:48
    s_add_u32 s36, s31, 20480
    buffer_load_dwordx4 v[196:199], v5, s[4:7], s36 offen offset:0
    ds_read_b128 v[92:95], v5 offset:52224
    s_waitcnt lgkmcnt(6)
    v_mfma_f32_32x32x16_bf16 v[32:47], v[96:99], v[80:83], v[32:47]
    ds_read_b128 v[64:67], v14 offset:128
    ds_read_b128 v[80:83], v5 offset:53248
    s_waitcnt lgkmcnt(6)
    v_mfma_f32_32x32x16_bf16 v[32:47], v[100:103], v[84:87], v[32:47]
    ds_read_b128 v[68:71], v14 offset:144
    s_add_u32 s36, s30, 20480
    buffer_load_dwordx4 v[200:203], v5, s[4:7], s36 offen offset:1024
    ds_read_b128 v[84:87], v5 offset:54272
    s_waitcnt lgkmcnt(6)
    v_mfma_f32_32x32x16_bf16 v[32:47], v[104:107], v[88:91], v[32:47]
    ds_read_b128 v[72:75], v14 offset:160
    ds_read_b128 v[88:91], v5 offset:55296
    s_waitcnt lgkmcnt(6)
    v_mfma_f32_32x32x16_bf16 v[32:47], v[108:111], v[92:95], v[32:47]
    ds_read_b128 v[76:79], v14 offset:176
    s_add_u32 s36, s31, 20480
    buffer_load_dwordx4 v[204:207], v5, s[4:7], s36 offen offset:1024
    ds_read_b128 v[92:95], v5 offset:56320
    s_waitcnt lgkmcnt(6)
    v_mfma_f32_32x32x16_bf16 v[32:47], v[112:115], v[80:83], v[32:47]
    s_waitcnt lgkmcnt(4)
    v_mfma_f32_32x32x16_bf16 v[32:47], v[116:119], v[84:87], v[32:47]
    s_waitcnt lgkmcnt(2)
    v_mfma_f32_32x32x16_bf16 v[32:47], v[120:123], v[88:91], v[32:47]
    s_waitcnt lgkmcnt(0)
    v_mfma_f32_32x32x16_bf16 v[32:47], v[124:127], v[92:95], v[32:47]
    s_setprio 0
    s_barrier
    s_nop 7
    v_fma_f32 v48, v11, v48, v64
    v_fma_f32 v49, v11, v49, v65
    v_fma_f32 v50, v11, v50, v66
    v_fma_f32 v51, v11, v51, v67
    v_fma_f32 v52, v11, v52, v68
    v_fma_f32 v53, v11, v53, v69
    v_fma_f32 v54, v11, v54, v70
    v_fma_f32 v55, v11, v55, v71
    v_fma_f32 v56, v11, v56, v72
    v_fma_f32 v57, v11, v57, v73
    v_fma_f32 v58, v11, v58, v74
    v_fma_f32 v59, v11, v59, v75
    v_fma_f32 v60, v11, v60, v76
    v_fma_f32 v61, v11, v61, v77
    v_fma_f32 v62, v11, v62, v78
    v_fma_f32 v63, v11, v63, v79
    v_fma_f32 v32, v10, v32, v48
    v_fma_f32 v33, v10, v33, v49
    v_fma_f32 v34, v10, v34, v50
    v_fma_f32 v35, v10, v35, v51
    v_fma_f32 v36, v10, v36, v52
    v_fma_f32 v37, v10, v37, v53
    v_fma_f32 v38, v10, v38, v54
    v_fma_f32 v39, v10, v39, v55
    v_fma_f32 v40, v10, v40, v56
    v_fma_f32 v41, v10, v41, v57
    v_fma_f32 v42, v10, v42, v58
    v_fma_f32 v43, v10, v43, v59
    v_fma_f32 v44, v10, v44, v60
    v_fma_f32 v45, v10, v45, v61
    v_fma_f32 v46, v10, v46, v62
    v_fma_f32 v47, v10, v47, v63
    v_exp_f32 v48, v32
    v_exp_f32 v49, v33
    v_exp_f32 v50, v34
    v_exp_f32 v51, v35
    v_exp_f32 v52, v36
    v_exp_f32 v53, v37
    v_exp_f32 v54, v38
    v_exp_f32 v55, v39
    v_exp_f32 v56, v40
    v_exp_f32 v57, v41
    v_exp_f32 v58, v42
    v_exp_f32 v59, v43
    v_exp_f32 v60, v44
    v_exp_f32 v61, v45
    v_exp_f32 v62, v46
    v_exp_f32 v63, v47
    v_add_f32 v48, 1.0, v48
    v_add_f32 v49, 1.0, v49
    v_add_f32 v50, 1.0, v50
    v_add_f32 v51, 1.0, v51
    v_add_f32 v52, 1.0, v52
    v_add_f32 v53, 1.0, v53
    v_add_f32 v54, 1.0, v54
    v_add_f32 v55, 1.0, v55
    v_add_f32 v56, 1.0, v56
    v_add_f32 v57, 1.0, v57
    v_add_f32 v58, 1.0, v58
    v_add_f32 v59, 1.0, v59
    v_add_f32 v60, 1.0, v60
    v_add_f32 v61, 1.0, v61
    v_add_f32 v62, 1.0, v62
    v_add_f32 v63, 1.0, v63
    v_fma_f32 v48, v48, v48, 1.0
    v_fma_f32 v49, v49, v49, 1.0
    v_fma_f32 v50, v50, v50, 1.0
    v_fma_f32 v51, v51, v51, 1.0
    v_fma_f32 v52, v52, v52, 1.0
    v_fma_f32 v53, v53, v53, 1.0
    v_fma_f32 v54, v54, v54, 1.0
    v_fma_f32 v55, v55, v55, 1.0
    v_fma_f32 v56, v56, v56, 1.0
    v_fma_f32 v57, v57, v57, 1.0
    v_fma_f32 v58, v58, v58, 1.0
    v_fma_f32 v59, v59, v59, 1.0
    v_fma_f32 v60, v60, v60, 1.0
    v_fma_f32 v61, v61, v61, 1.0
    v_fma_f32 v62, v62, v62, 1.0
    v_fma_f32 v63, v63, v63, 1.0
    v_rcp_f32 v48, v48
    v_rcp_f32 v49, v49
    v_rcp_f32 v50, v50
    v_rcp_f32 v51, v51
    v_rcp_f32 v52, v52
    v_rcp_f32 v53, v53
    v_rcp_f32 v54, v54
    v_rcp_f32 v55, v55
    v_rcp_f32 v56, v56
    v_rcp_f32 v57, v57
    v_rcp_f32 v58, v58
    v_rcp_f32 v59, v59
    v_rcp_f32 v60, v60
    v_rcp_f32 v61, v61
    v_rcp_f32 v62, v62
    v_rcp_f32 v63, v63
    v_fma_f32 v48, v48, v12, v13
    v_fma_f32 v49, v49, v12, v13
    v_fma_f32 v50, v50, v12, v13
    v_fma_f32 v51, v51, v12, v13
    v_fma_f32 v52, v52, v12, v13
    v_fma_f32 v53, v53, v12, v13
    v_fma_f32 v54, v54, v12, v13
    v_fma_f32 v55, v55, v12, v13
    v_fma_f32 v56, v56, v12, v13
    v_fma_f32 v57, v57, v12, v13
    v_fma_f32 v58, v58, v12, v13
    v_fma_f32 v59, v59, v12, v13
    v_fma_f32 v60, v60, v12, v13
    v_fma_f32 v61, v61, v12, v13
    v_fma_f32 v62, v62, v12, v13
    v_fma_f32 v63, v63, v12, v13
    v_mul_f32 v32, v32, v48
    v_mul_f32 v33, v33, v49
    v_mul_f32 v34, v34, v50
    v_mul_f32 v35, v35, v51
    v_mul_f32 v36, v36, v52
    v_mul_f32 v37, v37, v53
    v_mul_f32 v38, v38, v54
    v_mul_f32 v39, v39, v55
    v_mul_f32 v40, v40, v56
    v_mul_f32 v41, v41, v57
    v_mul_f32 v42, v42, v58
    v_mul_f32 v43, v43, v59
    v_mul_f32 v44, v44, v60
    v_mul_f32 v45, v45, v61
    v_mul_f32 v46, v46, v62
    v_mul_f32 v47, v47, v63
    v_cvt_pk_bf16_f32 v64, v32, v33
    v_cvt_pk_bf16_f32 v65, v34, v35
    v_cvt_pk_bf16_f32 v66, v36, v37
    v_cvt_pk_bf16_f32 v67, v38, v39
    v_cvt_pk_bf16_f32 v68, v40, v41
    v_cvt_pk_bf16_f32 v69, v42, v43
    v_cvt_pk_bf16_f32 v70, v44, v45
    v_cvt_pk_bf16_f32 v71, v46, v47
    s_cmp_eq_u32 s48, 0
    s_cbranch_scc1 hs_72
    buffer_store_dwordx4 v[64:67], v5, s[4:7], s39 offen
    buffer_store_dwordx4 v[68:71], v5, s[4:7], s39 offen offset:1024
    s_branch hs_73
hs_72:
    buffer_store_dwordx4 v[64:67], v5, s[4:7], s39 offen sc1
    buffer_store_dwordx4 v[68:71], v5, s[4:7], s39 offen offset:1024 sc1
hs_73:
fj_65:
    s_setprio 0
    s_lshl_b32 s24, s50, 7
    s_lshl_b32 s25, s51, 2
    s_add_u32 s24, s24, s25
    s_add_u32 s24, s24, s16
    s_add_u32 s24, s24, 8192
    s_waitcnt vmcnt(0)
    s_barrier
    s_cmp_lg_u32 s3, 0
    s_cbranch_scc1 pb_74
    s_mov_b32 exec_lo, 1
    s_mov_b32 exec_hi, 0
    v_mov_b32 v9, 1
    s_cmp_eq_u32 s17, 0
    s_cbranch_scc1 hs_75
    buffer_store_dword v9, off, s[4:7], s24
    s_branch hs_76
hs_75:
    buffer_store_dword v9, off, s[4:7], s24 sc1
hs_76:
    s_mov_b32 exec_lo, -1
    s_mov_b32 exec_hi, -1
pb_74:
    s_lshl_b32 s24, s50, 7
    s_add_u32 s24, s24, s16
    s_add_u32 s24, s24, 8192
    s_mul_i32 s25, s58, 112
    s_mul_i32 s26, s56, 28
    s_add_u32 s25, s25, s26
    s_lshl_b32 s25, s25, 10
    s_add_u32 s25, s25, s14
    s_add_u32 s25, s25, 0x2080000
    s_mul_i32 s26, s56, 24576
    s_add_u32 s26, s26, 65536
    v_add_u32 v12, s26, v5
    s_mul_i32 s26, s56, 12288
    v_add_u32 v13, s26, v5
    s_mul_i32 s60, s58, 28
    s_add_u32 s60, s60, s59
    s_lshl_b32 s60, s60, 10
    s_add_u32 s60, s60, s14
    s_add_u32 s60, s60, 0x12c0000
    buffer_load_dwordx4 v[80:83], v5, s[4:7], s60 offen sc1
    ds_read_b128 v[48:51], v12 offset:0
    ds_read_b128 v[52:55], v12 offset:1024
    ds_read_b128 v[56:59], v12 offset:2048
    ds_read_b128 v[60:63], v12 offset:3072
    ds_read_b128 v[64:67], v12 offset:4096
    ds_read_b128 v[68:71], v12 offset:5120
    ds_read_b128 v[72:75], v12 offset:6144
    ds_read_b128 v[76:79], v12 offset:7168
    s_cmp_lg_u32 s3, 0
    s_cbranch_scc1 pl_78
    s_mov_b32 exec_lo, 0x7f
    s_mov_b32 exec_hi, 0
    v_lshlrev_b32 v8, 2, v1
    s_mov_b32 s18, 0
    buffer_load_dword v96, v8, s[4:7], s24 offen sc1
    s_sleep 1
    buffer_load_dword v97, v8, s[4:7], s24 offen sc1
    s_sleep 1
    buffer_load_dword v98, v8, s[4:7], s24 offen sc1
pl_77:
    s_waitcnt vmcnt(2)
    v_cmp_eq_u32 vcc, 0, v96
    s_add_u32 s18, s18, 1
    s_nop 0
    s_cmp_eq_u32 vcc_lo, 0
    s_cbranch_scc1 pl_79
    buffer_load_dword v96, v8, s[4:7], s24 offen sc1
    s_waitcnt vmcnt(2)
    v_cmp_eq_u32 vcc, 0, v97
    s_add_u32 s18, s18, 1
    s_nop 0
    s_cmp_eq_u32 vcc_lo, 0
    s_cbranch_scc1 pl_79
    buffer_load_dword v97, v8, s[4:7], s24 offen sc1
    s_waitcnt vmcnt(2)
    v_cmp_eq_u32 vcc, 0, v98
    s_add_u32 s18, s18, 1
    s_nop 0
    s_cmp_eq_u32 vcc_lo, 0
    s_cbranch_scc1 pl_79
    buffer_load_dword v98, v8, s[4:7], s24 offen sc1
    s_cmp_lt_u32 s18, 32768
    s_cbranch_scc1 pl_77
pl_79:
    s_mov_b32 exec_lo, -1
    s_mov_b32 exec_hi, -1
pl_78:
    s_barrier
    s_add_u32 s27, s25, 4096
    buffer_load_dwordx4 v[96:99], v5, s[4:7], s27 offen offset:2048 sc1
    buffer_load_dwordx4 v[100:103], v5, s[4:7], s27 offen offset:3072 sc1
    s_add_u32 s27, s25, 8192
    buffer_load_dwordx4 v[104:107], v5, s[4:7], s27 offen offset:0 sc1
    buffer_load_dwordx4 v[108:111], v5, s[4:7], s27 offen offset:1024 sc1
    buffer_load_dwordx4 v[112:115], v5, s[4:7], s27 offen offset:2048 sc1
    buffer_load_dwordx4 v[116:119], v5, s[4:7], s27 offen offset:3072 sc1
    s_add_u32 s27, s25, 12288
    buffer_load_dwordx4 v[120:123], v5, s[4:7], s27 offen offset:0 sc1
    buffer_load_dwordx4 v[124:127], v5, s[4:7], s27 offen offset:1024 sc1
    buffer_load_dwordx4 v[208:211], v5, s[4:7], s27 offen offset:2048 sc1
    buffer_load_dwordx4 v[212:215], v5, s[4:7], s27 offen offset:3072 sc1
    s_add_u32 s27, s25, 16384
    buffer_load_dwordx4 v[216:219], v5, s[4:7], s27 offen offset:0 sc1
    buffer_load_dwordx4 v[220:223], v5, s[4:7], s27 offen offset:1024 sc1
    s_add_u32 s27, s25, 20480
    buffer_load_dwordx4 v[224:227], v5, s[4:7], s27 offen offset:2048 sc1
    buffer_load_dwordx4 v[228:231], v5, s[4:7], s27 offen offset:3072 sc1
    s_waitcnt vmcnt(13)
    s_waitcnt lgkmcnt(6)
    v_mfma_f32_32x32x16_bf16 v[16:31], v[48:51], v[96:99], 0
    v_mfma_f32_32x32x16_bf16 v[32:47], v[52:55], v[96:99], 0
    ds_read_b128 v[48:51], v12 offset:8192
    ds_read_b128 v[52:55], v12 offset:9216
    s_add_u32 s27, s25, 24576
    buffer_load_dwordx4 v[232:235], v5, s[4:7], s27 offen offset:0 sc1
    s_waitcnt vmcnt(13)
    s_waitcnt lgkmcnt(6)
    v_mfma_f32_32x32x16_bf16 v[16:31], v[56:59], v[100:103], v[16:31]
    v_mfma_f32_32x32x16_bf16 v[32:47], v[60:63], v[100:103], v[32:47]
    ds_read_b128 v[56:59], v12 offset:10240
    ds_read_b128 v[60:63], v12 offset:11264
    buffer_load_dwordx4 v[236:239], v5, s[4:7], s27 offen offset:1024 sc1
    s_waitcnt vmcnt(13)
    s_waitcnt lgkmcnt(6)
    v_mfma_f32_32x32x16_bf16 v[16:31], v[64:67], v[104:107], v[16:31]
    v_mfma_f32_32x32x16_bf16 v[32:47], v[68:71], v[104:107], v[32:47]
    ds_read_b128 v[64:67], v12 offset:12288
    ds_read_b128 v[68:71], v12 offset:13312
    buffer_load_dwordx4 v[240:243], v5, s[4:7], s27 offen offset:2048 sc1
    s_waitcnt vmcnt(13)
    s_waitcnt lgkmcnt(6)
    v_mfma_f32_32x32x16_bf16 v[16:31], v[72:75], v[108:111], v[16:31]
    v_mfma_f32_32x32x16_bf16 v[32:47], v[76:79], v[108:111], v[32:47]
    ds_read_b128 v[72:75], v12 offset:14336
    ds_read_b128 v[76:79], v12 offset:15360
    buffer_load_dwordx4 v[244:247], v5, s[4:7], s27 offen offset:3072 sc1
    s_waitcnt vmcnt(13)
    s_waitcnt lgkmcnt(6)
    v_mfma_f32_32x32x16_bf16 v[16:31], v[48:51], v[112:115], v[16:31]
    v_mfma_f32_32x32x16_bf16 v[32:47], v[52:55], v[112:115], v[32:47]
    ds_read_b128 v[48:51], v12 offset:16384
    ds_read_b128 v[52:55], v12 offset:17408
    s_add_u32 s27, s25, 0
    buffer_load_dwordx4 v[248:251], v5, s[4:7], s27 offen offset:0 sc1
    s_waitcnt vmcnt(13)
    s_waitcnt lgkmcnt(6)
    v_mfma_f32_32x32x16_bf16 v[16:31], v[56:59], v[116:119], v[16:31]
    v_mfma_f32_32x32x16_bf16 v[32:47], v[60:63], v[116:119], v[32:47]
    ds_read_b128 v[56:59], v12 offset:18432
    ds_read_b128 v[60:63], v12 offset:19456
    buffer_load_dwordx4 v[252:255], v5, s[4:7], s27 offen offset:1024 sc1
    s_waitcnt vmcnt(13)
    s_waitcnt lgkmcnt(6)
    v_mfma_f32_32x32x16_bf16 v[16:31], v[64:67], v[120:123], v[16:31]
    v_mfma_f32_32x32x16_bf16 v[32:47], v[68:71], v[120:123], v[32:47]
    ds_read_b128 v[64:67], v12 offset:20480
    ds_read_b128 v[68:71], v12 offset:21504
    buffer_load_dwordx4 v[96:99], v5, s[4:7], s27 offen offset:2048 sc1
    s_waitcnt vmcnt(13)
    s_waitcnt lgkmcnt(6)
    v_mfma_f32_32x32x16_bf16 v[16:31], v[72:75], v[124:127], v[16:31]
    v_mfma_f32_32x32x16_bf16 v[32:47], v[76:79], v[124:127], v[32:47]
    ds_read_b128 v[72:75], v12 offset:22528
    ds_read_b128 v[76:79], v12 offset:23552
    buffer_load_dwordx4 v[100:103], v5, s[4:7], s27 offen offset:3072 sc1
    s_waitcnt vmcnt(13)
    s_waitcnt lgkmcnt(6)
    v_mfma_f32_32x32x16_bf16 v[16:31], v[48:51], v[208:211], v[16:31]
    v_mfma_f32_32x32x16_bf16 v[32:47], v[52:55], v[208:211], v[32:47]
    ds_read_b128 v[48:51], v13 offset:0
    ds_read_b128 v[52:55], v13 offset:1024
    s_add_u32 s27, s25, 4096
    buffer_load_dwordx4 v[104:107], v5, s[4:7], s27 offen offset:0 sc1
    s_waitcnt vmcnt(13)
    s_waitcnt lgkmcnt(6)
    v_mfma_f32_32x32x16_bf16 v[16:31], v[56:59], v[212:215], v[16:31]
    v_mfma_f32_32x32x16_bf16 v[32:47], v[60:63], v[212:215], v[32:47]
    ds_read_b128 v[56:59], v13 offset:2048
    ds_read_b128 v[60:63], v13 offset:3072
    buffer_load_dwordx4 v[108:111], v5, s[4:7], s27 offen offset:1024 sc1
    s_waitcnt vmcnt(13)
    s_waitcnt lgkmcnt(6)
    v_mfma_f32_32x32x16_bf16 v[16:31], v[64:67], v[216:219], v[16:31]
    v_mfma_f32_32x32x16_bf16 v[32:47], v[68:71], v[216:219], v[32:47]
    ds_read_b128 v[64:67], v13 offset:4096
    ds_read_b128 v[68:71], v13 offset:5120
    s_add_u32 s27, s25, 16384
    buffer_load_dwordx4 v[112:115], v5, s[4:7], s27 offen offset:2048 sc1
    s_waitcnt vmcnt(13)
    s_waitcnt lgkmcnt(6)
    v_mfma_f32_32x32x16_bf16 v[16:31], v[72:75], v[220:223], v[16:31]
    v_mfma_f32_32x32x16_bf16 v[32:47], v[76:79], v[220:223], v[32:47]
    ds_read_b128 v[72:75], v13 offset:6144
    ds_read_b128 v[76:79], v13 offset:7168
    buffer_load_dwordx4 v[116:119], v5, s[4:7], s27 offen offset:3072 sc1
    s_waitcnt vmcnt(13)
    s_waitcnt lgkmcnt(6)
    v_mfma_f32_32x32x16_bf16 v[16:31], v[48:51], v[224:227], v[16:31]
    v_mfma_f32_32x32x16_bf16 v[32:47], v[52:55], v[224:227], v[32:47]
    ds_read_b128 v[48:51], v13 offset:8192
    ds_read_b128 v[52:55], v13 offset:9216
    s_add_u32 s27, s25, 20480
    buffer_load_dwordx4 v[120:123], v5, s[4:7], s27 offen offset:0 sc1
    s_waitcnt vmcnt(13)
    s_waitcnt lgkmcnt(6)
    v_mfma_f32_32x32x16_bf16 v[16:31], v[56:59], v[228:231], v[16:31]
    v_mfma_f32_32x32x16_bf16 v[32:47], v[60:63], v[228:231], v[32:47]
    ds_read_b128 v[56:59], v13 offset:10240
    ds_read_b128 v[60:63], v13 offset:11264
    buffer_load_dwordx4 v[124:127], v5, s[4:7], s27 offen offset:1024 sc1
    s_waitcnt vmcnt(13)
    s_waitcnt lgkmcnt(6)
    v_mfma_f32_32x32x16_bf16 v[16:31], v[64:67], v[232:235], v[16:31]
    v_mfma_f32_32x32x16_bf16 v[32:47], v[68:71], v[232:235], v[32:47]
    s_waitcnt vmcnt(12)
    s_waitcnt lgkmcnt(4)
    v_mfma_f32_32x32x16_bf16 v[16:31], v[72:75], v[236:239], v[16:31]
    v_mfma_f32_32x32x16_bf16 v[32:47], v[76:79], v[236:239], v[32:47]
    s_waitcnt vmcnt(11)
    s_waitcnt lgkmcnt(2)
    v_mfma_f32_32x32x16_bf16 v[16:31], v[48:51], v[240:243], v[16:31]
    v_mfma_f32_32x32x16_bf16 v[32:47], v[52:55], v[240:243], v[32:47]
    s_waitcnt vmcnt(10)
    s_waitcnt lgkmcnt(0)
    v_mfma_f32_32x32x16_bf16 v[16:31], v[56:59], v[244:247], v[16:31]
    v_mfma_f32_32x32x16_bf16 v[32:47], v[60:63], v[244:247], v[32:47]
    s_barrier
    s_cmp_lg_u32 s15, 0
    s_cbranch_scc1 np_80
    s_lshr_b32 s18, s13, 1
    s_mul_i32 s19, s18, 86016
    s_add_u32 s19, s19, 0x900000
    s_lshl_b32 s20, s3, 10
    s_add_u32 s19, s19, s20
    s_add_u32 s20, s20, 65536
    s_add_u32 m0, s20, 0
    s_add_u32 s21, s19, 0
    buffer_load_dwordx4 v5, s[4:7], s21 offen lds
    s_add_u32 m0, s20, 8192
    s_add_u32 s21, s19, 8192
    buffer_load_dwordx4 v5, s[4:7], s21 offen lds
    s_add_u32 m0, s20, 16384
    s_add_u32 s21, s19, 16384
    buffer_load_dwordx4 v5, s[4:7], s21 offen lds
    s_add_u32 m0, s20, 24576
    s_add_u32 s21, s19, 24576
    buffer_load_dwordx4 v5, s[4:7], s21 offen lds
    s_add_u32 m0, s20, 32768
    s_add_u32 s21, s19, 32768
    buffer_load_dwordx4 v5, s[4:7], s21 offen lds
    s_add_u32 m0, s20, 40960
    s_add_u32 s21, s19, 40960
    buffer_load_dwordx4 v5, s[4:7], s21 offen lds
    s_add_u32 m0, s20, 49152
    s_add_u32 s21, s19, 49152
    buffer_load_dwordx4 v5, s[4:7], s21 offen lds
    s_add_u32 m0, s20, 57344
    s_add_u32 s21, s19, 57344
    buffer_load_dwordx4 v5, s[4:7], s21 offen lds
    s_add_u32 m0, s20, 65536
    s_add_u32 s21, s19, 65536
    buffer_load_dwordx4 v5, s[4:7], s21 offen lds
    s_add_u32 m0, s20, 73728
    s_add_u32 s21, s19, 73728
    buffer_load_dwordx4 v5, s[4:7], s21 offen lds
    s_cmp_ge_u32 s3, 4
    s_cbranch_scc1 wq_82
    s_add_u32 m0, s20, 81920
    s_add_u32 s21, s19, 81920
    buffer_load_dwordx4 v5, s[4:7], s21 offen lds
    s_branch wq_83
wq_82:
    s_cmp_lg_u32 s3, 4
    s_cbranch_scc1 wq_83
    s_lshl_b32 s21, s18, 9
    s_add_u32 s21, s21, 0xf00000
    s_mov_b32 m0, 151552
    s_mov_b32 exec_hi, 0
    buffer_load_dwordx4 v5, s[4:7], s21 offen lds
    s_mov_b32 exec_hi, -1
wq_83:
    s_waitcnt vmcnt(19)
    v_mfma_f32_32x32x16_bf16 v[16:31], v[128:131], v[248:251], v[16:31]
    v_mfma_f32_32x32x16_bf16 v[32:47], v[132:135], v[248:251], v[32:47]
    s_waitcnt vmcnt(18)
    v_mfma_f32_32x32x16_bf16 v[16:31], v[136:139], v[252:255], v[16:31]
    v_mfma_f32_32x32x16_bf16 v[32:47], v[140:143], v[252:255], v[32:47]
    s_waitcnt vmcnt(17)
    v_mfma_f32_32x32x16_bf16 v[16:31], v[144:147], v[96:99], v[16:31]
    v_mfma_f32_32x32x16_bf16 v[32:47], v[148:151], v[96:99], v[32:47]
    s_waitcnt vmcnt(16)
    v_mfma_f32_32x32x16_bf16 v[16:31], v[152:155], v[100:103], v[16:31]
    v_mfma_f32_32x32x16_bf16 v[32:47], v[156:159], v[100:103], v[32:47]
    s_waitcnt vmcnt(15)
    v_mfma_f32_32x32x16_bf16 v[16:31], v[160:163], v[104:107], v[16:31]
    v_mfma_f32_32x32x16_bf16 v[32:47], v[164:167], v[104:107], v[32:47]
    s_waitcnt vmcnt(14)
    v_mfma_f32_32x32x16_bf16 v[16:31], v[168:171], v[108:111], v[16:31]
    v_mfma_f32_32x32x16_bf16 v[32:47], v[172:175], v[108:111], v[32:47]
    s_waitcnt vmcnt(13)
    v_mfma_f32_32x32x16_bf16 v[16:31], v[176:179], v[112:115], v[16:31]
    v_mfma_f32_32x32x16_bf16 v[32:47], v[180:183], v[112:115], v[32:47]
    s_waitcnt vmcnt(12)
    v_mfma_f32_32x32x16_bf16 v[16:31], v[184:187], v[116:119], v[16:31]
    v_mfma_f32_32x32x16_bf16 v[32:47], v[188:191], v[116:119], v[32:47]
    s_waitcnt vmcnt(11)
    v_mfma_f32_32x32x16_bf16 v[16:31], v[192:195], v[120:123], v[16:31]
    v_mfma_f32_32x32x16_bf16 v[32:47], v[196:199], v[120:123], v[32:47]
    s_waitcnt vmcnt(10)
    v_mfma_f32_32x32x16_bf16 v[16:31], v[200:203], v[124:127], v[16:31]
    v_mfma_f32_32x32x16_bf16 v[32:47], v[204:207], v[124:127], v[32:47]
    s_branch np_81
np_80:
    s_waitcnt vmcnt(9)
    v_mfma_f32_32x32x16_bf16 v[16:31], v[128:131], v[248:251], v[16:31]
    v_mfma_f32_32x32x16_bf16 v[32:47], v[132:135], v[248:251], v[32:47]
    s_waitcnt vmcnt(8)
    v_mfma_f32_32x32x16_bf16 v[16:31], v[136:139], v[252:255], v[16:31]
    v_mfma_f32_32x32x16_bf16 v[32:47], v[140:143], v[252:255], v[32:47]
    s_waitcnt vmcnt(7)
    v_mfma_f32_32x32x16_bf16 v[16:31], v[144:147], v[96:99], v[16:31]
    v_mfma_f32_32x32x16_bf16 v[32:47], v[148:151], v[96:99], v[32:47]
    s_waitcnt vmcnt(6)
    v_mfma_f32_32x32x16_bf16 v[16:31], v[152:155], v[100:103], v[16:31]
    v_mfma_f32_32x32x16_bf16 v[32:47], v[156:159], v[100:103], v[32:47]
    s_waitcnt vmcnt(5)
    v_mfma_f32_32x32x16_bf16 v[16:31], v[160:163], v[104:107], v[16:31]
    v_mfma_f32_32x32x16_bf16 v[32:47], v[164:167], v[104:107], v[32:47]
    s_waitcnt vmcnt(4)
    v_mfma_f32_32x32x16_bf16 v[16:31], v[168:171], v[108:111], v[16:31]
    v_mfma_f32_32x32x16_bf16 v[32:47], v[172:175], v[108:111], v[32:47]
    s_waitcnt vmcnt(3)
    v_mfma_f32_32x32x16_bf16 v[16:31], v[176:179], v[112:115], v[16:31]
    v_mfma_f32_32x32x16_bf16 v[32:47], v[180:183], v[112:115], v[32:47]
    s_waitcnt vmcnt(2)
    v_mfma_f32_32x32x16_bf16 v[16:31], v[184:187], v[116:119], v[16:31]
    v_mfma_f32_32x32x16_bf16 v[32:47], v[188:191], v[116:119], v[32:47]
    s_waitcnt vmcnt(1)
    v_mfma_f32_32x32x16_bf16 v[16:31], v[192:195], v[120:123], v[16:31]
    v_mfma_f32_32x32x16_bf16 v[32:47], v[196:199], v[120:123], v[32:47]
    s_waitcnt vmcnt(0)
    v_mfma_f32_32x32x16_bf16 v[16:31], v[200:203], v[124:127], v[16:31]
    v_mfma_f32_32x32x16_bf16 v[32:47], v[204:207], v[124:127], v[32:47]
np_81:
    s_nop 15
    s_lshl_b32 s60, s57, 15
    v_add_u32 v8, s60, v5
    s_cmp_eq_u32 s56, 1
    s_cbranch_scc1 ro_85
    s_cmp_eq_u32 s56, 2
    s_cbranch_scc1 ro_86
    s_cmp_eq_u32 s56, 3
    s_cbranch_scc1 ro_87
ro_84:
    ds_write_b128 v8, v[24:27] offset:12288
    ds_write_b128 v8, v[28:31] offset:13312
    ds_write_b128 v8, v[32:35] offset:18432
    ds_write_b128 v8, v[36:39] offset:19456
    ds_write_b128 v8, v[40:43] offset:24576
    ds_write_b128 v8, v[44:47] offset:25600
    v_mov_b32 v72, v16
    v_mov_b32 v73, v17
    v_mov_b32 v74, v18
    v_mov_b32 v75, v19
    v_mov_b32 v76, v20
    v_mov_b32 v77, v21
    v_mov_b32 v78, v22
    v_mov_b32 v79, v23
    s_branch ro_88
ro_85:
    ds_write_b128 v8, v[16:19] offset:0
    ds_write_b128 v8, v[20:23] offset:1024
    ds_write_b128 v8, v[32:35] offset:20480
    ds_write_b128 v8, v[36:39] offset:21504
    ds_write_b128 v8, v[40:43] offset:26624
    ds_write_b128 v8, v[44:47] offset:27648
    v_mov_b32 v72, v24
    v_mov_b32 v73, v25
    v_mov_b32 v74, v26
    v_mov_b32 v75, v27
    v_mov_b32 v76, v28
    v_mov_b32 v77, v29
    v_mov_b32 v78, v30
    v_mov_b32 v79, v31
    s_branch ro_88
ro_86:
    ds_write_b128 v8, v[16:19] offset:2048
    ds_write_b128 v8, v[20:23] offset:3072
    ds_write_b128 v8, v[24:27] offset:8192
    ds_write_b128 v8, v[28:31] offset:9216
    ds_write_b128 v8, v[40:43] offset:28672
    ds_write_b128 v8, v[44:47] offset:29696
    v_mov_b32 v72, v32
    v_mov_b32 v73, v33
    v_mov_b32 v74, v34
    v_mov_b32 v75, v35
    v_mov_b32 v76, v36
    v_mov_b32 v77, v37
    v_mov_b32 v78, v38
    v_mov_b32 v79, v39
    s_branch ro_88
ro_87:
    ds_write_b128 v8, v[16:19] offset:4096
    ds_write_b128 v8, v[20:23] offset:5120
    ds_write_b128 v8, v[24:27] offset:10240
    ds_write_b128 v8, v[28:31] offset:11264
    ds_write_b128 v8, v[32:35] offset:16384
    ds_write_b128 v8, v[36:39] offset:17408
    v_mov_b32 v72, v40
    v_mov_b32 v73, v41
    v_mov_b32 v74, v42
    v_mov_b32 v75, v43
    v_mov_b32 v76, v44
    v_mov_b32 v77, v45
    v_mov_b32 v78, v46
    v_mov_b32 v79, v47
ro_88:
    s_lshl_b32 s61, s56, 13
    s_add_u32 s61, s61, s60
    v_add_u32 v9, s61, v5
    s_mul_i32 s62, s58, 28
    s_add_u32 s62, s62, s59
    s_lshl_b32 s62, s62, 10
    s_add_u32 s62, s62, s14
    s_add_u32 s62, s62, 0x1000000
    s_lshr_b32 s63, s59, 1
    s_mul_i32 s60, s58, 14
    s_add_u32 s63, s63, s60
    s_lshl_b32 s63, s63, 9
    s_and_b32 s60, s59, 1
    s_lshl_b32 s60, s60, 3
    s_add_u32 s63, s63, s60
    s_add_u32 s63, s63, s14
    s_add_u32 s63, s63, 0x11c0000
    s_waitcnt lgkmcnt(0)
    s_barrier
    ds_read_b128 v[48:51], v9 offset:0
    ds_read_b128 v[52:55], v9 offset:1024
    ds_read_b128 v[56:59], v9 offset:2048
    ds_read_b128 v[60:63], v9 offset:3072
    ds_read_b128 v[64:67], v9 offset:4096
    ds_read_b128 v[68:71], v9 offset:5120
    v_lshlrev_b32 v16, 16, v80
    v_and_b32 v17, 0xffff0000, v80
    v_lshlrev_b32 v18, 16, v81
    v_and_b32 v19, 0xffff0000, v81
    v_lshlrev_b32 v20, 16, v82
    v_and_b32 v21, 0xffff0000, v82
    v_lshlrev_b32 v22, 16, v83
    v_and_b32 v23, 0xffff0000, v83
    v_add_f32 v16, v16, v72
    v_add_f32 v17, v17, v73
    v_add_f32 v18, v18, v74
    v_add_f32 v19, v19, v75
    v_add_f32 v20, v20, v76
    v_add_f32 v21, v21, v77
    v_add_f32 v22, v22, v78
    v_add_f32 v23, v23, v79
    s_waitcnt lgkmcnt(4)
    v_add_f32 v16, v16, v48
    v_add_f32 v17, v17, v49
    v_add_f32 v18, v18, v50
    v_add_f32 v19, v19, v51
    v_add_f32 v20, v20, v52
    v_add_f32 v21, v21, v53
    v_add_f32 v22, v22, v54
    v_add_f32 v23, v23, v55
    s_waitcnt lgkmcnt(2)
    v_add_f32 v16, v16, v56
    v_add_f32 v17, v17, v57
    v_add_f32 v18, v18, v58
    v_add_f32 v19, v19, v59
    v_add_f32 v20, v20, v60
    v_add_f32 v21, v21, v61
    v_add_f32 v22, v22, v62
    v_add_f32 v23, v23, v63
    s_waitcnt lgkmcnt(0)
    v_add_f32 v16, v16, v64
    v_add_f32 v17, v17, v65
    v_add_f32 v18, v18, v66
    v_add_f32 v19, v19, v67
    v_add_f32 v20, v20, v68
    v_add_f32 v21, v21, v69
    v_add_f32 v22, v22, v70
    v_add_f32 v23, v23, v71
    v_cvt_pk_bf16_f32 v48, v16, v17
    v_cvt_pk_bf16_f32 v49, v18, v19
    v_cvt_pk_bf16_f32 v50, v20, v21
    v_cvt_pk_bf16_f32 v51, v22, v23
    s_cmp_lg_u32 s15, 0
    s_cbranch_scc1 rf_89
    s_cmp_eq_u32 s17, 0
    s_cbranch_scc1 hs_91
    buffer_store_dwordx4 v[48:51], v5, s[4:7], s62 offen
    s_branch hs_92
hs_91:
    buffer_store_dwordx4 v[48:51], v5, s[4:7], s62 offen sc1
hs_92:
    v_add_f32 v8, v16, v17
    v_mul_f32 v9, v16, v16
    v_fmac_f32 v9, v17, v17
    v_add_f32 v10, v18, v19
    v_mul_f32 v11, v18, v18
    v_fmac_f32 v11, v19, v19
    v_add_f32 v8, v8, v20
    v_fmac_f32 v9, v20, v20
    v_add_f32 v10, v10, v21
    v_fmac_f32 v11, v21, v21
    v_add_f32 v8, v8, v22
    v_fmac_f32 v9, v22, v22
    v_add_f32 v10, v10, v23
    v_fmac_f32 v11, v23, v23
    v_add_f32 v8, v8, v10
    v_add_f32 v9, v9, v11
    v_mov_b32 v10, v8
    s_nop 1
    v_permlane32_swap_b32 v8, v10
    s_nop 0
    v_add_f32 v8, v8, v10
    v_mov_b32 v10, v9
    s_nop 1
    v_permlane32_swap_b32 v9, v10
    s_nop 0
    v_add_f32 v9, v9, v10
    v_lshlrev_b32 v10, 4, v4
    s_mov_b32 exec_hi, 0
    s_cmp_eq_u32 s17, 0
    s_cbranch_scc1 hs_93
    buffer_store_dwordx2 v[8:9], v10, s[4:7], s63 offen
    s_branch hs_94
hs_93:
    buffer_store_dwordx2 v[8:9], v10, s[4:7], s63 offen sc1
hs_94:
    s_mov_b32 exec_hi, -1
    s_branch re_90
rf_89:
    s_nop 1
    v_permlane32_swap_b32 v48, v50
    v_permlane32_swap_b32 v49, v51
    v_mul_u32_u24 v10, 896, v4
    v_lshl_add_u32 v10, v3, 4, v10
    s_mul_i32 s62, s58, 28672
    s_lshl_b32 s63, s59, 5
    s_add_u32 s62, s62, s63
    buffer_store_dwordx4 v[48:51], v10, s[8:11], s62 offen
re_90:
    s_lshr_b32 s24, s50, 1
    s_lshl_b32 s24, s24, 7
    s_and_b32 s25, s50, 1
    s_mul_i32 s25, s25, 7
    s_add_u32 s25, s25, s51
    s_lshl_b32 s25, s25, 2
    s_add_u32 s24, s24, s25
    s_add_u32 s24, s24, s16
    s_add_u32 s24, s24, 12288
    s_waitcnt vmcnt(0)
    s_cmp_lg_u32 s15, 0
    s_cbranch_scc1 fin_16
    s_barrier
    s_cmp_lg_u32 s3, 0
    s_cbranch_scc1 pb_95
    s_mov_b32 exec_lo, 1
    s_mov_b32 exec_hi, 0
    v_mov_b32 v9, 1
    s_cmp_eq_u32 s17, 0
    s_cbranch_scc1 hs_96
    buffer_store_dword v9, off, s[4:7], s24
    s_branch hs_97
hs_96:
    buffer_store_dword v9, off, s[4:7], s24 sc1
hs_97:
    s_mov_b32 exec_lo, -1
    s_mov_b32 exec_hi, -1
pb_95:
    s_branch next_15
idle_14:
    s_cmp_lg_u32 s15, 0
    s_cbranch_scc1 fin_16
    s_lshr_b32 s18, s13, 1
    s_mul_i32 s19, s18, 86016
    s_add_u32 s19, s19, 0x900000
    s_lshl_b32 s20, s3, 10
    s_add_u32 s19, s19, s20
    s_add_u32 s20, s20, 65536
    s_add_u32 m0, s20, 0
    s_add_u32 s21, s19, 0
    buffer_load_dwordx4 v5, s[4:7], s21 offen lds
    s_add_u32 m0, s20, 8192
    s_add_u32 s21, s19, 8192
    buffer_load_dwordx4 v5, s[4:7], s21 offen lds
    s_add_u32 m0, s20, 16384
    s_add_u32 s21, s19, 16384
    buffer_load_dwordx4 v5, s[4:7], s21 offen lds
    s_add_u32 m0, s20, 24576
    s_add_u32 s21, s19, 24576
    buffer_load_dwordx4 v5, s[4:7], s21 offen lds
    s_add_u32 m0, s20, 32768
    s_add_u32 s21, s19, 32768
    buffer_load_dwordx4 v5, s[4:7], s21 offen lds
    s_add_u32 m0, s20, 40960
    s_add_u32 s21, s19, 40960
    buffer_load_dwordx4 v5, s[4:7], s21 offen lds
    s_add_u32 m0, s20, 49152
    s_add_u32 s21, s19, 49152
    buffer_load_dwordx4 v5, s[4:7], s21 offen lds
    s_add_u32 m0, s20, 57344
    s_add_u32 s21, s19, 57344
    buffer_load_dwordx4 v5, s[4:7], s21 offen lds
    s_add_u32 m0, s20, 65536
    s_add_u32 s21, s19, 65536
    buffer_load_dwordx4 v5, s[4:7], s21 offen lds
    s_add_u32 m0, s20, 73728
    s_add_u32 s21, s19, 73728
    buffer_load_dwordx4 v5, s[4:7], s21 offen lds
    s_cmp_ge_u32 s3, 4
    s_cbranch_scc1 wq_98
    s_add_u32 m0, s20, 81920
    s_add_u32 s21, s19, 81920
    buffer_load_dwordx4 v5, s[4:7], s21 offen lds
    s_branch wq_99
wq_98:
    s_cmp_lg_u32 s3, 4
    s_cbranch_scc1 wq_99
    s_lshl_b32 s21, s18, 9
    s_add_u32 s21, s21, 0xf00000
    s_mov_b32 m0, 151552
    s_mov_b32 exec_hi, 0
    buffer_load_dwordx4 v5, s[4:7], s21 offen lds
    s_mov_b32 exec_hi, -1
wq_99:
next_15:
    s_cmp_lg_u32 s15, 0
    s_cbranch_scc1 fin_16
    s_mov_b32 s15, 1
    s_mov_b32 s14, 0x0
    s_mov_b32 s47, 0x400000
    s_mov_b32 s16, 16007168
    s_branch top_13
fin_16:
main_kernel_end:
    s_endpgm
.section .rodata,"a"
.p2align 6
.amdhsa_kernel interleave_layers__softmax_full_mha__dense_activation_mish__prompt_kernel
  .amdhsa_next_free_vgpr 128
  .amdhsa_next_free_sgpr 100
  .amdhsa_accum_offset 128
  .amdhsa_group_segment_fixed_size 0
  .amdhsa_kernarg_size 80
  .amdhsa_user_sgpr_count 2
  .amdhsa_user_sgpr_kernarg_segment_ptr 1
  .amdhsa_system_sgpr_workgroup_id_x 1
.end_amdhsa_kernel
.p2align 6
.amdhsa_kernel main_kernel
  .amdhsa_next_free_vgpr 256
  .amdhsa_next_free_sgpr 100
  .amdhsa_accum_offset 256
  .amdhsa_group_segment_fixed_size 0
  .amdhsa_kernarg_size 80
  .amdhsa_user_sgpr_count 2
  .amdhsa_user_sgpr_kernarg_segment_ptr 1
  .amdhsa_system_sgpr_workgroup_id_x 1
.end_amdhsa_kernel
```
